```python
import torch

def _softmax(x, axis=-1):
    return torch.softmax(x, dim=axis)
def _gelu(x):
    return torch.nn.functional.gelu(x, approximate="tanh")
def _silu(x):
    return torch.nn.functional.silu(x)
def _sigmoid(x):
    return torch.sigmoid(x)
def _layernorm(x, axis=-1, eps=1e-5):
    m = x.mean(dim=axis, keepdim=True)
    v = x.var(dim=axis, keepdim=True, unbiased=False)
    return (x - m) / torch.sqrt(v + eps)
def _scatter_add(tgt, idx, src, axis=0):
    return tgt.clone().index_add_(axis, idx, src)
def _segment_sum(src, seg, n):
    out = torch.zeros((n,) + src.shape[1:], dtype=src.dtype)
    return out.index_add_(0, seg, src)
def _pad(x, pw):
    flat = tuple(v for pair in reversed(pw) for v in pair)
    return torch.nn.functional.pad(x, flat)

kernel_name = 'parallel_sum__sliding_block__glu_gated_reglu__prompt'

def setup_inputs():

    _w = (lambda a: (lambda t: t.to(torch.bfloat16) if t.is_floating_point() else t)(torch.as_tensor(a)))
    def _A_setup():
        B, S, D = 1, 2048, 1024
        return {
            "x": _w((lambda *s: torch.randn(*s, dtype=torch.bfloat16) * 0.05)(B, S, D)),
            "wqkv": _w((lambda *s: torch.randn(*s, dtype=torch.bfloat16) * 0.05)(D, 3 * D)),
            "wo": _w((lambda *s: torch.randn(*s, dtype=torch.bfloat16) * 0.05)(D, D)),
        }
    _A_in = _A_setup()

    def _B_setup():
        B, S, D, F = 1, 2048, 1024, 3584
        return {
            "x": _w((lambda *s: torch.randn(*s, dtype=torch.bfloat16) * 0.05)(B, S, D)),
            "W_gate": _w((lambda *s: torch.randn(*s, dtype=torch.bfloat16) * 0.8)(D, F) * (2.0 / D) ** 0.5),
            "W_up": _w((lambda *s: torch.randn(*s, dtype=torch.bfloat16) * 0.8)(D, F) * (2.0 / D) ** 0.5),
            "W_down": _w((lambda *s: torch.randn(*s, dtype=torch.bfloat16) * 0.8)(F, D) * (1.0 / F) ** 0.5),
        }
    _B_in = _B_setup()

    return {
        "A_x": _A_in["x"],
        "A_wqkv": _A_in["wqkv"],
        "A_wo": _A_in["wo"],
        "B_x": _B_in["x"],
        "B_W_gate": _B_in["W_gate"],
        "B_W_up": _B_in["W_up"],
        "B_W_down": _B_in["W_down"],
    }

def reference(A_x, A_wqkv, A_wo, B_x, B_W_gate, B_W_up, B_W_down):
    def _A_ref(x, wqkv, wo):
        B, S, D = x.shape
        H = 32; Dh = D // H; W = 256
        qkv = (lambda x, *d: x.permute(*d))((x @ wqkv).reshape(B, S, 3, H, Dh), 2, 0, 3, 1, 4)
        q, k, v = qkv[0], qkv[1], qkv[2]
        scores = torch.einsum("bhqd,bhkd->bhqk", q, k) * (Dh ** -0.5)
        idx = torch.arange(S)
        mask = (idx[:, None] - idx[None, :] >= 0) & (idx[:, None] - idx[None, :] < W)
        scores = torch.where(mask[None, None], scores, -1e9)
        p = _softmax(scores, axis=-1)
        o = torch.einsum("bhqk,bhkd->bhqd", p, v)
        return (lambda x, *d: x.permute(*d))(o, 0, 2, 1, 3).reshape(B, S, D) @ wo

    def _B_ref(x, W_gate, W_up, W_down):
        gate = torch.einsum("bsd,df->bsf", x, W_gate)
        up = torch.einsum("bsd,df->bsf", x, W_up)
        gate = gate * (lambda x, dt: x.to(dt))(gate > 0, gate.dtype)
        h = gate * up
        return torch.einsum("bsf,fd->bsd", h, W_down)

    x = A_x
    xn = _layernorm(x, axis=-1)
    return x + _A_ref(xn, A_wqkv, A_wo) + _B_ref(xn, B_W_gate, B_W_up, B_W_down)
```

```asm
; @launch kernel=ln_kernel grid=(512,1,1) block=(256,1,1) lds=0
; @launch kernel=gemm1_kernel grid=(256,1,1) block=(512,1,1) lds=147456
; @launch kernel=attn_kernel grid=(512,1,1) block=(256,1,1) lds=24576
; @launch kernel=gemm2_kernel grid=(256,1,1) block=(512,1,1) lds=147456
; @launch kernel=comb_kernel grid=(512,1,1) block=(256,1,1) lds=0
.amdgcn_target "amdgcn-amd-amdhsa--gfx950"
.text
.globl ln_kernel
.p2align 8
.type ln_kernel,@function
ln_kernel:
    s_cmp_ge_u32 s2, 512
    s_cbranch_scc1 L_ln_done
    s_load_dwordx2 s[4:5], s[0:1], 0
    s_load_dwordx2 s[6:7], s[0:1], 72
    v_lshrrev_b32 v1, 6, v0
    v_and_b32 v2, 63, v0
    s_lshl_b32 s3, s2, 2
    v_add_u32 v40, s3, v1
    v_lshlrev_b32 v1, 11, v40
    v_lshl_add_u32 v1, v2, 5, v1
    v_xor_b32 v3, 32, v2
    v_lshlrev_b32 v3, 2, v3
    v_lshrrev_b32 v41, 8, v40
    v_lshlrev_b32 v41, 5, v41
    v_lshrrev_b32 v42, 1, v2
    v_add_u32 v41, v41, v42
    v_lshlrev_b32 v41, 8, v41
    v_and_b32 v42, 255, v40
    v_add_u32 v41, v41, v42
    v_lshlrev_b32 v41, 6, v41
    v_bfe_u32 v42, v40, 2, 2
    v_and_b32 v43, 1, v2
    v_lshlrev_b32 v43, 1, v43
    v_xor_b32 v44, v43, v42
    v_lshl_add_u32 v44, v44, 4, v41
    v_or_b32 v43, 1, v43
    v_xor_b32 v45, v43, v42
    v_lshl_add_u32 v45, v45, 4, v41
    s_waitcnt lgkmcnt(0)
    s_mov_b32 s8, s4
    s_mov_b32 s9, s5
    s_mov_b32 s10, 4194304
    s_mov_b32 s11, 0x00020000
    s_mov_b32 s12, s6
    s_mov_b32 s13, s7
    s_mov_b32 s14, 4194304
    s_mov_b32 s15, 0x00020000
    buffer_load_dwordx4 v[4:7], v1, s[8:11], 0 offen
    buffer_load_dwordx4 v[8:11], v1, s[8:11], 0 offen offset:16
    s_waitcnt vmcnt(0)
    v_lshlrev_b32 v16, 16, v4
    v_and_b32 v17, 0xffff0000, v4
    v_lshlrev_b32 v18, 16, v5
    v_and_b32 v19, 0xffff0000, v5
    v_lshlrev_b32 v20, 16, v6
    v_and_b32 v21, 0xffff0000, v6
    v_lshlrev_b32 v22, 16, v7
    v_and_b32 v23, 0xffff0000, v7
    v_lshlrev_b32 v24, 16, v8
    v_and_b32 v25, 0xffff0000, v8
    v_lshlrev_b32 v26, 16, v9
    v_and_b32 v27, 0xffff0000, v9
    v_lshlrev_b32 v28, 16, v10
    v_and_b32 v29, 0xffff0000, v10
    v_lshlrev_b32 v30, 16, v11
    v_and_b32 v31, 0xffff0000, v11
    v_add_f32 v32, v16, v17
    v_add_f32 v32, v32, v18
    v_add_f32 v32, v32, v19
    v_add_f32 v32, v32, v20
    v_add_f32 v32, v32, v21
    v_add_f32 v32, v32, v22
    v_add_f32 v32, v32, v23
    v_add_f32 v32, v32, v24
    v_add_f32 v32, v32, v25
    v_add_f32 v32, v32, v26
    v_add_f32 v32, v32, v27
    v_add_f32 v32, v32, v28
    v_add_f32 v32, v32, v29
    v_add_f32 v32, v32, v30
    v_add_f32 v32, v32, v31
    s_nop 1
    v_add_f32_dpp v32, v32, v32 quad_perm:[1,0,3,2] row_mask:0xf bank_mask:0xf
    s_nop 1
    v_add_f32_dpp v32, v32, v32 quad_perm:[2,3,0,1] row_mask:0xf bank_mask:0xf
    s_nop 1
    v_add_f32_dpp v32, v32, v32 row_half_mirror row_mask:0xf bank_mask:0xf
    s_nop 1
    v_add_f32_dpp v32, v32, v32 row_mirror row_mask:0xf bank_mask:0xf
    s_nop 1
    v_readlane_b32 s40, v32, 0
    v_readlane_b32 s41, v32, 16
    v_readlane_b32 s42, v32, 32
    v_readlane_b32 s43, v32, 48
    s_nop 1
    v_mov_b32 v32, s40
    v_add_f32 v32, s41, v32
    v_add_f32 v32, s42, v32
    v_add_f32 v32, s43, v32
    v_mul_f32 v32, 0x3a800000, v32
    v_sub_f32 v35, v16, v32
    v_mul_f32 v34, v35, v35
    v_sub_f32 v35, v17, v32
    v_fmac_f32 v34, v35, v35
    v_sub_f32 v35, v18, v32
    v_fmac_f32 v34, v35, v35
    v_sub_f32 v35, v19, v32
    v_fmac_f32 v34, v35, v35
    v_sub_f32 v35, v20, v32
    v_fmac_f32 v34, v35, v35
    v_sub_f32 v35, v21, v32
    v_fmac_f32 v34, v35, v35
    v_sub_f32 v35, v22, v32
    v_fmac_f32 v34, v35, v35
    v_sub_f32 v35, v23, v32
    v_fmac_f32 v34, v35, v35
    v_sub_f32 v35, v24, v32
    v_fmac_f32 v34, v35, v35
    v_sub_f32 v35, v25, v32
    v_fmac_f32 v34, v35, v35
    v_sub_f32 v35, v26, v32
    v_fmac_f32 v34, v35, v35
    v_sub_f32 v35, v27, v32
    v_fmac_f32 v34, v35, v35
    v_sub_f32 v35, v28, v32
    v_fmac_f32 v34, v35, v35
    v_sub_f32 v35, v29, v32
    v_fmac_f32 v34, v35, v35
    v_sub_f32 v35, v30, v32
    v_fmac_f32 v34, v35, v35
    v_sub_f32 v35, v31, v32
    v_fmac_f32 v34, v35, v35
    s_nop 1
    v_add_f32_dpp v34, v34, v34 quad_perm:[1,0,3,2] row_mask:0xf bank_mask:0xf
    s_nop 1
    v_add_f32_dpp v34, v34, v34 quad_perm:[2,3,0,1] row_mask:0xf bank_mask:0xf
    s_nop 1
    v_add_f32_dpp v34, v34, v34 row_half_mirror row_mask:0xf bank_mask:0xf
    s_nop 1
    v_add_f32_dpp v34, v34, v34 row_mirror row_mask:0xf bank_mask:0xf
    s_nop 1
    v_readlane_b32 s40, v34, 0
    v_readlane_b32 s41, v34, 16
    v_readlane_b32 s42, v34, 32
    v_readlane_b32 s43, v34, 48
    s_nop 1
    v_mov_b32 v34, s40
    v_add_f32 v34, s41, v34
    v_add_f32 v34, s42, v34
    v_add_f32 v34, s43, v34
    v_mul_f32 v34, 0x3a800000, v34
    v_cvt_pk_bf16_f32 v32, v32, v32
    v_lshlrev_b32 v32, 16, v32
    v_cvt_pk_bf16_f32 v34, v34, v34
    v_lshlrev_b32 v34, 16, v34
    v_add_f32 v34, 0x3727c5ac, v34
    v_cvt_pk_bf16_f32 v34, v34, v34
    v_lshlrev_b32 v34, 16, v34
    v_sqrt_f32 v34, v34
    s_nop 0
    v_cvt_pk_bf16_f32 v34, v34, v34
    v_lshlrev_b32 v34, 16, v34
    v_rcp_f32 v34, v34
    s_nop 0
    v_sub_f32 v16, v16, v32
    v_sub_f32 v17, v17, v32
    v_sub_f32 v18, v18, v32
    v_sub_f32 v19, v19, v32
    v_sub_f32 v20, v20, v32
    v_sub_f32 v21, v21, v32
    v_sub_f32 v22, v22, v32
    v_sub_f32 v23, v23, v32
    v_sub_f32 v24, v24, v32
    v_sub_f32 v25, v25, v32
    v_sub_f32 v26, v26, v32
    v_sub_f32 v27, v27, v32
    v_sub_f32 v28, v28, v32
    v_sub_f32 v29, v29, v32
    v_sub_f32 v30, v30, v32
    v_sub_f32 v31, v31, v32
    v_cvt_pk_bf16_f32 v16, v16, v16
    v_lshlrev_b32 v16, 16, v16
    v_cvt_pk_bf16_f32 v17, v17, v17
    v_lshlrev_b32 v17, 16, v17
    v_cvt_pk_bf16_f32 v18, v18, v18
    v_lshlrev_b32 v18, 16, v18
    v_cvt_pk_bf16_f32 v19, v19, v19
    v_lshlrev_b32 v19, 16, v19
    v_cvt_pk_bf16_f32 v20, v20, v20
    v_lshlrev_b32 v20, 16, v20
    v_cvt_pk_bf16_f32 v21, v21, v21
    v_lshlrev_b32 v21, 16, v21
    v_cvt_pk_bf16_f32 v22, v22, v22
    v_lshlrev_b32 v22, 16, v22
    v_cvt_pk_bf16_f32 v23, v23, v23
    v_lshlrev_b32 v23, 16, v23
    v_cvt_pk_bf16_f32 v24, v24, v24
    v_lshlrev_b32 v24, 16, v24
    v_cvt_pk_bf16_f32 v25, v25, v25
    v_lshlrev_b32 v25, 16, v25
    v_cvt_pk_bf16_f32 v26, v26, v26
    v_lshlrev_b32 v26, 16, v26
    v_cvt_pk_bf16_f32 v27, v27, v27
    v_lshlrev_b32 v27, 16, v27
    v_cvt_pk_bf16_f32 v28, v28, v28
    v_lshlrev_b32 v28, 16, v28
    v_cvt_pk_bf16_f32 v29, v29, v29
    v_lshlrev_b32 v29, 16, v29
    v_cvt_pk_bf16_f32 v30, v30, v30
    v_lshlrev_b32 v30, 16, v30
    v_cvt_pk_bf16_f32 v31, v31, v31
    v_lshlrev_b32 v31, 16, v31
    v_mul_f32 v16, v16, v34
    v_mul_f32 v17, v17, v34
    v_mul_f32 v18, v18, v34
    v_mul_f32 v19, v19, v34
    v_mul_f32 v20, v20, v34
    v_mul_f32 v21, v21, v34
    v_mul_f32 v22, v22, v34
    v_mul_f32 v23, v23, v34
    v_mul_f32 v24, v24, v34
    v_mul_f32 v25, v25, v34
    v_mul_f32 v26, v26, v34
    v_mul_f32 v27, v27, v34
    v_mul_f32 v28, v28, v34
    v_mul_f32 v29, v29, v34
    v_mul_f32 v30, v30, v34
    v_mul_f32 v31, v31, v34
    v_cvt_pk_bf16_f32 v4, v16, v17
    v_cvt_pk_bf16_f32 v5, v18, v19
    v_cvt_pk_bf16_f32 v6, v20, v21
    v_cvt_pk_bf16_f32 v7, v22, v23
    v_cvt_pk_bf16_f32 v8, v24, v25
    v_cvt_pk_bf16_f32 v9, v26, v27
    v_cvt_pk_bf16_f32 v10, v28, v29
    v_cvt_pk_bf16_f32 v11, v30, v31
    buffer_store_dwordx4 v[4:7], v44, s[12:15], 0 offen
    buffer_store_dwordx4 v[8:11], v45, s[12:15], 0 offen
L_ln_done:
    s_endpgm
.globl gemm1_kernel
.p2align 8
.type gemm1_kernel,@function
gemm1_kernel:
    s_cmp_ge_u32 s2, 256
    s_cbranch_scc1 L_g1_done
    s_load_dwordx2 s[4:5], s[0:1], 8
    s_load_dwordx2 s[6:7], s[0:1], 32
    s_load_dwordx2 s[24:25], s[0:1], 40
    s_load_dwordx2 s[26:27], s[0:1], 72
    v_lshrrev_b32 v1, 6, v0
    v_and_b32 v2, 63, v0
    s_nop 0
    v_readfirstlane_b32 s20, v1
    s_and_b32 s3, s2, 7
    s_lshr_b32 s18, s2, 3
    s_and_b32 s30, s18, 7
    s_lshr_b32 s18, s18, 3
    s_lshl_b32 s31, s3, 2
    s_add_u32 s31, s31, s18
    s_lshr_b32 s21, s20, 2
    s_waitcnt lgkmcnt(0)
    s_mov_b32 s8, s26
    s_mov_b32 s9, s27
    s_mov_b32 s10, 4194304
    s_mov_b32 s11, 0x00020000
    s_lshl_b32 s16, s30, 19
    s_cmp_lt_u32 s31, 28
    s_cbranch_scc0 L_g1_typeB
    s_lshl_b32 s18, s31, 8
    s_add_u32 s19, s18, 0
    s_add_u32 s64, s6, s19
    s_addc_u32 s65, s7, 0
    s_sub_u32 s66, 7340032, s19
    s_movk_i32 s84, 7168
    s_add_u32 s19, s18, 0
    s_add_u32 s68, s24, s19
    s_addc_u32 s69, s25, 0
    s_sub_u32 s70, 7340032, s19
    s_movk_i32 s85, 7168
    s_add_u32 s19, s18, 128
    s_add_u32 s72, s6, s19
    s_addc_u32 s73, s7, 0
    s_sub_u32 s74, 7340032, s19
    s_movk_i32 s86, 7168
    s_add_u32 s19, s18, 128
    s_add_u32 s76, s24, s19
    s_addc_u32 s77, s25, 0
    s_sub_u32 s78, 7340032, s19
    s_movk_i32 s87, 7168
    s_lshl_b32 s19, s31, 7
    s_add_u32 s80, s4, s19
    s_addc_u32 s81, s5, 0
    s_sub_u32 s82, 6291456, s19
    s_movk_i32 s88, 6144
    s_branch L_g1_wdone
L_g1_typeB:
    s_sub_u32 s18, s31, 28
    s_mul_i32 s18, s18, 640
    s_add_u32 s18, s18, 3584
    s_add_u32 s19, s18, 0
    s_add_u32 s64, s4, s19
    s_addc_u32 s65, s5, 0
    s_sub_u32 s66, 6291456, s19
    s_movk_i32 s84, 6144
    s_add_u32 s19, s18, 128
    s_add_u32 s68, s4, s19
    s_addc_u32 s69, s5, 0
    s_sub_u32 s70, 6291456, s19
    s_movk_i32 s85, 6144
    s_add_u32 s19, s18, 256
    s_add_u32 s72, s4, s19
    s_addc_u32 s73, s5, 0
    s_sub_u32 s74, 6291456, s19
    s_movk_i32 s86, 6144
    s_add_u32 s19, s18, 384
    s_add_u32 s76, s4, s19
    s_addc_u32 s77, s5, 0
    s_sub_u32 s78, 6291456, s19
    s_movk_i32 s87, 6144
    s_add_u32 s19, s18, 512
    s_add_u32 s80, s4, s19
    s_addc_u32 s81, s5, 0
    s_sub_u32 s82, 6291456, s19
    s_movk_i32 s88, 6144
L_g1_wdone:
    s_mov_b32 s67, 0x00020000
    s_mov_b32 s90, 0
    s_lshl_b32 s95, s84, 5
    s_mov_b32 s71, 0x00020000
    s_mov_b32 s91, 0
    s_lshl_b32 s96, s85, 5
    s_mov_b32 s75, 0x00020000
    s_mov_b32 s92, 0
    s_lshl_b32 s97, s86, 5
    s_mov_b32 s79, 0x00020000
    s_mov_b32 s93, 0
    s_lshl_b32 s98, s87, 5
    s_mov_b32 s83, 0x00020000
    s_mov_b32 s94, 0
    s_lshl_b32 s99, s88, 5
    s_lshl_b32 s35, s20, 11
    v_lshl_add_u32 v4, v2, 4, s35
    v_lshrrev_b32 v30, 3, v2
    v_and_b32 v31, 7, v2
    v_lshrrev_b32 v32, 4, v2
    s_and_b32 s35, s20, 3
    s_lshl_b32 s23, s35, 10
    s_lshl_b32 s35, s35, 3
    v_add_u32 v33, s35, v30
    v_and_b32 v34, 1, v32
    v_lshlrev_b32 v34, 2, v34
    v_xor_b32 v34, v34, v31
    v_lshlrev_b32 v34, 4, v34
    v_mul_lo_u32 v35, v33, s84
    v_add_u32 v5, v35, v34
    v_mul_lo_u32 v35, v33, s85
    v_add_u32 v6, v35, v34
    v_mul_lo_u32 v35, v33, s86
    v_add_u32 v7, v35, v34
    v_mul_lo_u32 v35, v33, s87
    v_add_u32 v8, v35, v34
    v_mul_lo_u32 v35, v33, s88
    v_add_u32 v9, v35, v34
    v_and_b32 v30, 31, v2
    v_lshrrev_b32 v31, 5, v2
    s_lshr_b32 s35, s20, 1
    s_lshl_b32 s35, s35, 6
    v_add_u32 v32, s35, v30
    v_lshlrev_b32 v32, 6, v32
    v_bfe_u32 v33, v30, 2, 2
    v_or_b32 v34, 0, v31
    v_xor_b32 v34, v34, v33
    v_lshl_add_u32 v10, v34, 4, v32
    v_add_u32 v12, 36864, v10
    v_add_u32 v14, 73728, v10
    v_add_u32 v16, 110592, v10
    v_or_b32 v34, 2, v31
    v_xor_b32 v34, v34, v33
    v_lshl_add_u32 v11, v34, 4, v32
    v_add_u32 v13, 36864, v11
    v_add_u32 v15, 73728, v11
    v_add_u32 v17, 110592, v11
    v_bfe_u32 v30, v2, 2, 2
    v_lshrrev_b32 v31, 5, v2
    v_lshl_add_u32 v31, v31, 3, v30
    v_lshlrev_b32 v31, 7, v31
    v_and_b32 v33, 1, v2
    v_lshl_add_u32 v31, v33, 3, v31
    v_add_u32 v31, 16384, v31
    v_bfe_u32 v32, v2, 4, 1
    v_bfe_u32 v33, v2, 1, 1
    v_lshl_add_u32 v32, v32, 1, v33
    v_bfe_u32 v33, v2, 3, 1
    v_lshlrev_b32 v33, 2, v33
    s_and_b32 s35, s20, 1
    s_lshl_b32 s36, s35, 13
    s_lshl_b32 s35, s35, 2
    v_or_b32 v34, 0, v32
    v_xor_b32 v34, v34, v33
    v_lshl_add_u32 v18, v34, 4, v31
    v_add_u32 v18, s36, v18
    v_or_b32 v34, 4, v32
    v_xor_b32 v34, v34, v33
    v_lshl_add_u32 v19, v34, 4, v31
    v_add_u32 v19, s36, v19
    v_or_b32 v34, s35, v32
    v_xor_b32 v34, v34, v33
    v_lshl_add_u32 v20, v34, 4, v31
    v_add_u32 v20, 16384, v20
    v_add_u32 v21, 36864, v18
    v_add_u32 v22, 36864, v19
    v_add_u32 v23, 36864, v20
    v_add_u32 v24, 73728, v18
    v_add_u32 v25, 73728, v19
    v_add_u32 v26, 73728, v20
    v_add_u32 v27, 110592, v18
    v_add_u32 v28, 110592, v19
    v_add_u32 v29, 110592, v20
    v_mov_b32 v92, 0
    v_mov_b32 v93, 0
    v_mov_b32 v94, 0
    v_mov_b32 v95, 0
    v_mov_b32 v96, 0
    v_mov_b32 v97, 0
    v_mov_b32 v98, 0
    v_mov_b32 v99, 0
    v_mov_b32 v100, 0
    v_mov_b32 v101, 0
    v_mov_b32 v102, 0
    v_mov_b32 v103, 0
    v_mov_b32 v104, 0
    v_mov_b32 v105, 0
    v_mov_b32 v106, 0
    v_mov_b32 v107, 0
    v_mov_b32 v108, 0
    v_mov_b32 v109, 0
    v_mov_b32 v110, 0
    v_mov_b32 v111, 0
    v_mov_b32 v112, 0
    v_mov_b32 v113, 0
    v_mov_b32 v114, 0
    v_mov_b32 v115, 0
    v_mov_b32 v116, 0
    v_mov_b32 v117, 0
    v_mov_b32 v118, 0
    v_mov_b32 v119, 0
    v_mov_b32 v120, 0
    v_mov_b32 v121, 0
    v_mov_b32 v122, 0
    v_mov_b32 v123, 0
    v_mov_b32 v124, 0
    v_mov_b32 v125, 0
    v_mov_b32 v126, 0
    v_mov_b32 v127, 0
    v_mov_b32 v128, 0
    v_mov_b32 v129, 0
    v_mov_b32 v130, 0
    v_mov_b32 v131, 0
    v_mov_b32 v132, 0
    v_mov_b32 v133, 0
    v_mov_b32 v134, 0
    v_mov_b32 v135, 0
    v_mov_b32 v136, 0
    v_mov_b32 v137, 0
    v_mov_b32 v138, 0
    v_mov_b32 v139, 0
    v_mov_b32 v140, 0
    v_mov_b32 v141, 0
    v_mov_b32 v142, 0
    v_mov_b32 v143, 0
    v_mov_b32 v144, 0
    v_mov_b32 v145, 0
    v_mov_b32 v146, 0
    v_mov_b32 v147, 0
    v_mov_b32 v148, 0
    v_mov_b32 v149, 0
    v_mov_b32 v150, 0
    v_mov_b32 v151, 0
    v_mov_b32 v152, 0
    v_mov_b32 v153, 0
    v_mov_b32 v154, 0
    v_mov_b32 v155, 0
    v_mov_b32 v156, 0
    v_mov_b32 v157, 0
    v_mov_b32 v158, 0
    v_mov_b32 v159, 0
    v_mov_b32 v160, 0
    v_mov_b32 v161, 0
    v_mov_b32 v162, 0
    v_mov_b32 v163, 0
    v_mov_b32 v164, 0
    v_mov_b32 v165, 0
    v_mov_b32 v166, 0
    v_mov_b32 v167, 0
    v_mov_b32 v168, 0
    v_mov_b32 v169, 0
    v_mov_b32 v170, 0
    v_mov_b32 v171, 0
    v_mov_b32 v172, 0
    v_mov_b32 v173, 0
    v_mov_b32 v174, 0
    v_mov_b32 v175, 0
    v_mov_b32 v176, 0
    v_mov_b32 v177, 0
    v_mov_b32 v178, 0
    v_mov_b32 v179, 0
    v_mov_b32 v180, 0
    v_mov_b32 v181, 0
    v_mov_b32 v182, 0
    v_mov_b32 v183, 0
    v_mov_b32 v184, 0
    v_mov_b32 v185, 0
    v_mov_b32 v186, 0
    v_mov_b32 v187, 0
    v_mov_b32 v188, 0
    v_mov_b32 v189, 0
    v_mov_b32 v190, 0
    v_mov_b32 v191, 0
    v_mov_b32 v192, 0
    v_mov_b32 v193, 0
    v_mov_b32 v194, 0
    v_mov_b32 v195, 0
    v_mov_b32 v196, 0
    v_mov_b32 v197, 0
    v_mov_b32 v198, 0
    v_mov_b32 v199, 0
    v_mov_b32 v200, 0
    v_mov_b32 v201, 0
    v_mov_b32 v202, 0
    v_mov_b32 v203, 0
    v_mov_b32 v204, 0
    v_mov_b32 v205, 0
    v_mov_b32 v206, 0
    v_mov_b32 v207, 0
    v_mov_b32 v208, 0
    v_mov_b32 v209, 0
    v_mov_b32 v210, 0
    v_mov_b32 v211, 0
    v_mov_b32 v212, 0
    v_mov_b32 v213, 0
    v_mov_b32 v214, 0
    v_mov_b32 v215, 0
    v_mov_b32 v216, 0
    v_mov_b32 v217, 0
    v_mov_b32 v218, 0
    v_mov_b32 v219, 0
    v_mov_b32 v220, 0
    v_mov_b32 v221, 0
    v_mov_b32 v222, 0
    v_mov_b32 v223, 0
    v_mov_b32 v224, 0
    v_mov_b32 v225, 0
    v_mov_b32 v226, 0
    v_mov_b32 v227, 0
    v_mov_b32 v228, 0
    v_mov_b32 v229, 0
    v_mov_b32 v230, 0
    v_mov_b32 v231, 0
    v_mov_b32 v232, 0
    v_mov_b32 v233, 0
    v_mov_b32 v234, 0
    v_mov_b32 v235, 0
    v_mov_b32 v236, 0
    v_mov_b32 v237, 0
    v_mov_b32 v238, 0
    v_mov_b32 v239, 0
    v_mov_b32 v240, 0
    v_mov_b32 v241, 0
    v_mov_b32 v242, 0
    v_mov_b32 v243, 0
    v_mov_b32 v244, 0
    v_mov_b32 v245, 0
    v_mov_b32 v246, 0
    v_mov_b32 v247, 0
    v_mov_b32 v248, 0
    v_mov_b32 v249, 0
    v_mov_b32 v250, 0
    v_mov_b32 v251, 0
    s_lshl_b32 s22, s20, 11
    s_add_u32 m0, s22, 0
    s_nop 0
    buffer_load_dwordx4 v4, s[8:11], s16 offen lds
    buffer_load_dwordx4 v4, s[8:11], s16 offen offset:1024 lds
    s_cmp_eq_u32 s21, 0
    s_cbranch_scc0 L_g1_d_1
    s_add_u32 m0, s23, 16384
    s_nop 0
    buffer_load_dwordx4 v5, s[64:67], s90 offen lds
    s_add_u32 m0, s23, 20480
    s_nop 0
    buffer_load_dwordx4 v6, s[68:71], s91 offen lds
    s_add_u32 m0, s23, 24576
    s_nop 0
    buffer_load_dwordx4 v7, s[72:75], s92 offen lds
    s_branch L_g1_e_2
L_g1_d_1:
    s_add_u32 m0, s23, 28672
    s_nop 0
    buffer_load_dwordx4 v8, s[76:79], s93 offen lds
    s_add_u32 m0, s23, 32768
    s_nop 0
    buffer_load_dwordx4 v9, s[80:83], s94 offen lds
L_g1_e_2:
    s_add_u32 s16, s16, 16384
    s_add_u32 s90, s90, s95
    s_add_u32 s91, s91, s96
    s_add_u32 s92, s92, s97
    s_add_u32 s93, s93, s98
    s_add_u32 s94, s94, s99
    s_add_u32 m0, s22, 36864
    s_nop 0
    buffer_load_dwordx4 v4, s[8:11], s16 offen lds
    buffer_load_dwordx4 v4, s[8:11], s16 offen offset:1024 lds
    s_cmp_eq_u32 s21, 1
    s_cbranch_scc0 L_g1_d_3
    s_add_u32 m0, s23, 53248
    s_nop 0
    buffer_load_dwordx4 v5, s[64:67], s90 offen lds
    s_add_u32 m0, s23, 57344
    s_nop 0
    buffer_load_dwordx4 v6, s[68:71], s91 offen lds
    s_add_u32 m0, s23, 61440
    s_nop 0
    buffer_load_dwordx4 v7, s[72:75], s92 offen lds
    s_branch L_g1_e_4
L_g1_d_3:
    s_add_u32 m0, s23, 65536
    s_nop 0
    buffer_load_dwordx4 v8, s[76:79], s93 offen lds
    s_add_u32 m0, s23, 69632
    s_nop 0
    buffer_load_dwordx4 v9, s[80:83], s94 offen lds
L_g1_e_4:
    s_add_u32 s16, s16, 16384
    s_add_u32 s90, s90, s95
    s_add_u32 s91, s91, s96
    s_add_u32 s92, s92, s97
    s_add_u32 s93, s93, s98
    s_add_u32 s94, s94, s99
    s_add_u32 m0, s22, 73728
    s_nop 0
    buffer_load_dwordx4 v4, s[8:11], s16 offen lds
    buffer_load_dwordx4 v4, s[8:11], s16 offen offset:1024 lds
    s_cmp_eq_u32 s21, 0
    s_cbranch_scc0 L_g1_d_5
    s_add_u32 m0, s23, 90112
    s_nop 0
    buffer_load_dwordx4 v5, s[64:67], s90 offen lds
    s_add_u32 m0, s23, 94208
    s_nop 0
    buffer_load_dwordx4 v6, s[68:71], s91 offen lds
    s_add_u32 m0, s23, 98304
    s_nop 0
    buffer_load_dwordx4 v7, s[72:75], s92 offen lds
    s_branch L_g1_e_6
L_g1_d_5:
    s_add_u32 m0, s23, 102400
    s_nop 0
    buffer_load_dwordx4 v8, s[76:79], s93 offen lds
    s_add_u32 m0, s23, 106496
    s_nop 0
    buffer_load_dwordx4 v9, s[80:83], s94 offen lds
L_g1_e_6:
    s_add_u32 s16, s16, 16384
    s_add_u32 s90, s90, s95
    s_add_u32 s91, s91, s96
    s_add_u32 s92, s92, s97
    s_add_u32 s93, s93, s98
    s_add_u32 s94, s94, s99
    s_waitcnt vmcnt(4)
    s_barrier
    ds_read_b64_tr_b16 v[36:37], v18 offset:0
    ds_read_b64_tr_b16 v[38:39], v18 offset:512
    ds_read_b64_tr_b16 v[40:41], v19 offset:0
    ds_read_b64_tr_b16 v[42:43], v19 offset:512
    ds_read_b64_tr_b16 v[44:45], v18 offset:4096
    ds_read_b64_tr_b16 v[46:47], v18 offset:4608
    ds_read_b64_tr_b16 v[48:49], v19 offset:4096
    ds_read_b64_tr_b16 v[50:51], v19 offset:4608
    ds_read_b64_tr_b16 v[52:53], v20 offset:0
    ds_read_b64_tr_b16 v[54:55], v20 offset:512
    ds_read_b128 v[56:59], v10 offset:0
    ds_read_b128 v[60:63], v10 offset:2048
    s_movk_i32 s37, 7
L_g1_loop:
    s_waitcnt lgkmcnt(0)
    v_mfma_f32_32x32x16_bf16 v[92:107], v[36:39], v[56:59], v[92:107]
    ds_read_b128 v[84:87], v11 offset:0
    ds_read_b128 v[88:91], v11 offset:2048
    v_mfma_f32_32x32x16_bf16 v[124:139], v[40:43], v[56:59], v[124:139]
    ds_read_b64_tr_b16 v[64:65], v18 offset:2048
    ds_read_b64_tr_b16 v[66:67], v18 offset:2560
    v_mfma_f32_32x32x16_bf16 v[156:171], v[44:47], v[56:59], v[156:171]
    ds_read_b64_tr_b16 v[68:69], v19 offset:2048
    ds_read_b64_tr_b16 v[70:71], v19 offset:2560
    v_mfma_f32_32x32x16_bf16 v[188:203], v[48:51], v[56:59], v[188:203]
    ds_read_b64_tr_b16 v[72:73], v18 offset:6144
    ds_read_b64_tr_b16 v[74:75], v18 offset:6656
    v_mfma_f32_32x32x16_bf16 v[220:235], v[52:55], v[56:59], v[220:235]
    ds_read_b64_tr_b16 v[76:77], v19 offset:6144
    ds_read_b64_tr_b16 v[78:79], v19 offset:6656
    v_mfma_f32_32x32x16_bf16 v[108:123], v[36:39], v[60:63], v[108:123]
    ds_read_b64_tr_b16 v[80:81], v20 offset:2048
    ds_read_b64_tr_b16 v[82:83], v20 offset:2560
    v_mfma_f32_32x32x16_bf16 v[140:155], v[40:43], v[60:63], v[140:155]
    s_add_u32 m0, s22, 110592
    s_nop 0
    buffer_load_dwordx4 v4, s[8:11], s16 offen lds
    buffer_load_dwordx4 v4, s[8:11], s16 offen offset:1024 lds
    s_cmp_eq_u32 s21, 1
    s_cbranch_scc0 L_g1_d_7
    s_add_u32 m0, s23, 126976
    s_nop 0
    buffer_load_dwordx4 v5, s[64:67], s90 offen lds
    s_add_u32 m0, s23, 131072
    s_nop 0
    buffer_load_dwordx4 v6, s[68:71], s91 offen lds
    s_add_u32 m0, s23, 135168
    s_nop 0
    buffer_load_dwordx4 v7, s[72:75], s92 offen lds
    s_branch L_g1_e_8
L_g1_d_7:
    s_add_u32 m0, s23, 139264
    s_nop 0
    buffer_load_dwordx4 v8, s[76:79], s93 offen lds
    s_add_u32 m0, s23, 143360
    s_nop 0
    buffer_load_dwordx4 v9, s[80:83], s94 offen lds
L_g1_e_8:
    s_add_u32 s16, s16, 16384
    s_add_u32 s90, s90, s95
    s_add_u32 s91, s91, s96
    s_add_u32 s92, s92, s97
    s_add_u32 s93, s93, s98
    s_add_u32 s94, s94, s99
    v_mfma_f32_32x32x16_bf16 v[172:187], v[44:47], v[60:63], v[172:187]
    v_mfma_f32_32x32x16_bf16 v[204:219], v[48:51], v[60:63], v[204:219]
    v_mfma_f32_32x32x16_bf16 v[236:251], v[52:55], v[60:63], v[236:251]
    s_waitcnt lgkmcnt(0)
    v_mfma_f32_32x32x16_bf16 v[92:107], v[64:67], v[84:87], v[92:107]
    ds_read_b128 v[56:59], v12 offset:0
    ds_read_b128 v[60:63], v12 offset:2048
    v_mfma_f32_32x32x16_bf16 v[124:139], v[68:71], v[84:87], v[124:139]
    ds_read_b64_tr_b16 v[36:37], v21 offset:0
    ds_read_b64_tr_b16 v[38:39], v21 offset:512
    v_mfma_f32_32x32x16_bf16 v[156:171], v[72:75], v[84:87], v[156:171]
    ds_read_b64_tr_b16 v[40:41], v22 offset:0
    ds_read_b64_tr_b16 v[42:43], v22 offset:512
    v_mfma_f32_32x32x16_bf16 v[188:203], v[76:79], v[84:87], v[188:203]
    ds_read_b64_tr_b16 v[44:45], v21 offset:4096
    ds_read_b64_tr_b16 v[46:47], v21 offset:4608
    v_mfma_f32_32x32x16_bf16 v[220:235], v[80:83], v[84:87], v[220:235]
    ds_read_b64_tr_b16 v[48:49], v22 offset:4096
    ds_read_b64_tr_b16 v[50:51], v22 offset:4608
    v_mfma_f32_32x32x16_bf16 v[108:123], v[64:67], v[88:91], v[108:123]
    ds_read_b64_tr_b16 v[52:53], v23 offset:0
    ds_read_b64_tr_b16 v[54:55], v23 offset:512
    v_mfma_f32_32x32x16_bf16 v[140:155], v[68:71], v[88:91], v[140:155]
    v_mfma_f32_32x32x16_bf16 v[172:187], v[72:75], v[88:91], v[172:187]
    v_mfma_f32_32x32x16_bf16 v[204:219], v[76:79], v[88:91], v[204:219]
    v_mfma_f32_32x32x16_bf16 v[236:251], v[80:83], v[88:91], v[236:251]
    s_waitcnt vmcnt(4)
    s_barrier
    s_waitcnt lgkmcnt(0)
    v_mfma_f32_32x32x16_bf16 v[92:107], v[36:39], v[56:59], v[92:107]
    ds_read_b128 v[84:87], v13 offset:0
    ds_read_b128 v[88:91], v13 offset:2048
    v_mfma_f32_32x32x16_bf16 v[124:139], v[40:43], v[56:59], v[124:139]
    ds_read_b64_tr_b16 v[64:65], v21 offset:2048
    ds_read_b64_tr_b16 v[66:67], v21 offset:2560
    v_mfma_f32_32x32x16_bf16 v[156:171], v[44:47], v[56:59], v[156:171]
    ds_read_b64_tr_b16 v[68:69], v22 offset:2048
    ds_read_b64_tr_b16 v[70:71], v22 offset:2560
    v_mfma_f32_32x32x16_bf16 v[188:203], v[48:51], v[56:59], v[188:203]
    ds_read_b64_tr_b16 v[72:73], v21 offset:6144
    ds_read_b64_tr_b16 v[74:75], v21 offset:6656
    v_mfma_f32_32x32x16_bf16 v[220:235], v[52:55], v[56:59], v[220:235]
    ds_read_b64_tr_b16 v[76:77], v22 offset:6144
    ds_read_b64_tr_b16 v[78:79], v22 offset:6656
    v_mfma_f32_32x32x16_bf16 v[108:123], v[36:39], v[60:63], v[108:123]
    ds_read_b64_tr_b16 v[80:81], v23 offset:2048
    ds_read_b64_tr_b16 v[82:83], v23 offset:2560
    v_mfma_f32_32x32x16_bf16 v[140:155], v[40:43], v[60:63], v[140:155]
    s_add_u32 m0, s22, 0
    s_nop 0
    buffer_load_dwordx4 v4, s[8:11], s16 offen lds
    buffer_load_dwordx4 v4, s[8:11], s16 offen offset:1024 lds
    s_cmp_eq_u32 s21, 0
    s_cbranch_scc0 L_g1_d_9
    s_add_u32 m0, s23, 16384
    s_nop 0
    buffer_load_dwordx4 v5, s[64:67], s90 offen lds
    s_add_u32 m0, s23, 20480
    s_nop 0
    buffer_load_dwordx4 v6, s[68:71], s91 offen lds
    s_add_u32 m0, s23, 24576
    s_nop 0
    buffer_load_dwordx4 v7, s[72:75], s92 offen lds
    s_branch L_g1_e_10
L_g1_d_9:
    s_add_u32 m0, s23, 28672
    s_nop 0
    buffer_load_dwordx4 v8, s[76:79], s93 offen lds
    s_add_u32 m0, s23, 32768
    s_nop 0
    buffer_load_dwordx4 v9, s[80:83], s94 offen lds
L_g1_e_10:
    s_add_u32 s16, s16, 16384
    s_add_u32 s90, s90, s95
    s_add_u32 s91, s91, s96
    s_add_u32 s92, s92, s97
    s_add_u32 s93, s93, s98
    s_add_u32 s94, s94, s99
    v_mfma_f32_32x32x16_bf16 v[172:187], v[44:47], v[60:63], v[172:187]
    v_mfma_f32_32x32x16_bf16 v[204:219], v[48:51], v[60:63], v[204:219]
    v_mfma_f32_32x32x16_bf16 v[236:251], v[52:55], v[60:63], v[236:251]
    s_waitcnt lgkmcnt(0)
    v_mfma_f32_32x32x16_bf16 v[92:107], v[64:67], v[84:87], v[92:107]
    ds_read_b128 v[56:59], v14 offset:0
    ds_read_b128 v[60:63], v14 offset:2048
    v_mfma_f32_32x32x16_bf16 v[124:139], v[68:71], v[84:87], v[124:139]
    ds_read_b64_tr_b16 v[36:37], v24 offset:0
    ds_read_b64_tr_b16 v[38:39], v24 offset:512
    v_mfma_f32_32x32x16_bf16 v[156:171], v[72:75], v[84:87], v[156:171]
    ds_read_b64_tr_b16 v[40:41], v25 offset:0
    ds_read_b64_tr_b16 v[42:43], v25 offset:512
    v_mfma_f32_32x32x16_bf16 v[188:203], v[76:79], v[84:87], v[188:203]
    ds_read_b64_tr_b16 v[44:45], v24 offset:4096
    ds_read_b64_tr_b16 v[46:47], v24 offset:4608
    v_mfma_f32_32x32x16_bf16 v[220:235], v[80:83], v[84:87], v[220:235]
    ds_read_b64_tr_b16 v[48:49], v25 offset:4096
    ds_read_b64_tr_b16 v[50:51], v25 offset:4608
    v_mfma_f32_32x32x16_bf16 v[108:123], v[64:67], v[88:91], v[108:123]
    ds_read_b64_tr_b16 v[52:53], v26 offset:0
    ds_read_b64_tr_b16 v[54:55], v26 offset:512
    v_mfma_f32_32x32x16_bf16 v[140:155], v[68:71], v[88:91], v[140:155]
    v_mfma_f32_32x32x16_bf16 v[172:187], v[72:75], v[88:91], v[172:187]
    v_mfma_f32_32x32x16_bf16 v[204:219], v[76:79], v[88:91], v[204:219]
    v_mfma_f32_32x32x16_bf16 v[236:251], v[80:83], v[88:91], v[236:251]
    s_waitcnt vmcnt(4)
    s_barrier
    s_waitcnt lgkmcnt(0)
    v_mfma_f32_32x32x16_bf16 v[92:107], v[36:39], v[56:59], v[92:107]
    ds_read_b128 v[84:87], v15 offset:0
    ds_read_b128 v[88:91], v15 offset:2048
    v_mfma_f32_32x32x16_bf16 v[124:139], v[40:43], v[56:59], v[124:139]
    ds_read_b64_tr_b16 v[64:65], v24 offset:2048
    ds_read_b64_tr_b16 v[66:67], v24 offset:2560
    v_mfma_f32_32x32x16_bf16 v[156:171], v[44:47], v[56:59], v[156:171]
    ds_read_b64_tr_b16 v[68:69], v25 offset:2048
    ds_read_b64_tr_b16 v[70:71], v25 offset:2560
    v_mfma_f32_32x32x16_bf16 v[188:203], v[48:51], v[56:59], v[188:203]
    ds_read_b64_tr_b16 v[72:73], v24 offset:6144
    ds_read_b64_tr_b16 v[74:75], v24 offset:6656
    v_mfma_f32_32x32x16_bf16 v[220:235], v[52:55], v[56:59], v[220:235]
    ds_read_b64_tr_b16 v[76:77], v25 offset:6144
    ds_read_b64_tr_b16 v[78:79], v25 offset:6656
    v_mfma_f32_32x32x16_bf16 v[108:123], v[36:39], v[60:63], v[108:123]
    ds_read_b64_tr_b16 v[80:81], v26 offset:2048
    ds_read_b64_tr_b16 v[82:83], v26 offset:2560
    v_mfma_f32_32x32x16_bf16 v[140:155], v[40:43], v[60:63], v[140:155]
    s_add_u32 m0, s22, 36864
    s_nop 0
    buffer_load_dwordx4 v4, s[8:11], s16 offen lds
    buffer_load_dwordx4 v4, s[8:11], s16 offen offset:1024 lds
    s_cmp_eq_u32 s21, 1
    s_cbranch_scc0 L_g1_d_11
    s_add_u32 m0, s23, 53248
    s_nop 0
    buffer_load_dwordx4 v5, s[64:67], s90 offen lds
    s_add_u32 m0, s23, 57344
    s_nop 0
    buffer_load_dwordx4 v6, s[68:71], s91 offen lds
    s_add_u32 m0, s23, 61440
    s_nop 0
    buffer_load_dwordx4 v7, s[72:75], s92 offen lds
    s_branch L_g1_e_12
L_g1_d_11:
    s_add_u32 m0, s23, 65536
    s_nop 0
    buffer_load_dwordx4 v8, s[76:79], s93 offen lds
    s_add_u32 m0, s23, 69632
    s_nop 0
    buffer_load_dwordx4 v9, s[80:83], s94 offen lds
L_g1_e_12:
    s_add_u32 s16, s16, 16384
    s_add_u32 s90, s90, s95
    s_add_u32 s91, s91, s96
    s_add_u32 s92, s92, s97
    s_add_u32 s93, s93, s98
    s_add_u32 s94, s94, s99
    v_mfma_f32_32x32x16_bf16 v[172:187], v[44:47], v[60:63], v[172:187]
    v_mfma_f32_32x32x16_bf16 v[204:219], v[48:51], v[60:63], v[204:219]
    v_mfma_f32_32x32x16_bf16 v[236:251], v[52:55], v[60:63], v[236:251]
    s_waitcnt lgkmcnt(0)
    v_mfma_f32_32x32x16_bf16 v[92:107], v[64:67], v[84:87], v[92:107]
    ds_read_b128 v[56:59], v16 offset:0
    ds_read_b128 v[60:63], v16 offset:2048
    v_mfma_f32_32x32x16_bf16 v[124:139], v[68:71], v[84:87], v[124:139]
    ds_read_b64_tr_b16 v[36:37], v27 offset:0
    ds_read_b64_tr_b16 v[38:39], v27 offset:512
    v_mfma_f32_32x32x16_bf16 v[156:171], v[72:75], v[84:87], v[156:171]
    ds_read_b64_tr_b16 v[40:41], v28 offset:0
    ds_read_b64_tr_b16 v[42:43], v28 offset:512
    v_mfma_f32_32x32x16_bf16 v[188:203], v[76:79], v[84:87], v[188:203]
    ds_read_b64_tr_b16 v[44:45], v27 offset:4096
    ds_read_b64_tr_b16 v[46:47], v27 offset:4608
    v_mfma_f32_32x32x16_bf16 v[220:235], v[80:83], v[84:87], v[220:235]
    ds_read_b64_tr_b16 v[48:49], v28 offset:4096
    ds_read_b64_tr_b16 v[50:51], v28 offset:4608
    v_mfma_f32_32x32x16_bf16 v[108:123], v[64:67], v[88:91], v[108:123]
    ds_read_b64_tr_b16 v[52:53], v29 offset:0
    ds_read_b64_tr_b16 v[54:55], v29 offset:512
    v_mfma_f32_32x32x16_bf16 v[140:155], v[68:71], v[88:91], v[140:155]
    v_mfma_f32_32x32x16_bf16 v[172:187], v[72:75], v[88:91], v[172:187]
    v_mfma_f32_32x32x16_bf16 v[204:219], v[76:79], v[88:91], v[204:219]
    v_mfma_f32_32x32x16_bf16 v[236:251], v[80:83], v[88:91], v[236:251]
    s_waitcnt vmcnt(4)
    s_barrier
    s_waitcnt lgkmcnt(0)
    v_mfma_f32_32x32x16_bf16 v[92:107], v[36:39], v[56:59], v[92:107]
    ds_read_b128 v[84:87], v17 offset:0
    ds_read_b128 v[88:91], v17 offset:2048
    v_mfma_f32_32x32x16_bf16 v[124:139], v[40:43], v[56:59], v[124:139]
    ds_read_b64_tr_b16 v[64:65], v27 offset:2048
    ds_read_b64_tr_b16 v[66:67], v27 offset:2560
    v_mfma_f32_32x32x16_bf16 v[156:171], v[44:47], v[56:59], v[156:171]
    ds_read_b64_tr_b16 v[68:69], v28 offset:2048
    ds_read_b64_tr_b16 v[70:71], v28 offset:2560
    v_mfma_f32_32x32x16_bf16 v[188:203], v[48:51], v[56:59], v[188:203]
    ds_read_b64_tr_b16 v[72:73], v27 offset:6144
    ds_read_b64_tr_b16 v[74:75], v27 offset:6656
    v_mfma_f32_32x32x16_bf16 v[220:235], v[52:55], v[56:59], v[220:235]
    ds_read_b64_tr_b16 v[76:77], v28 offset:6144
    ds_read_b64_tr_b16 v[78:79], v28 offset:6656
    v_mfma_f32_32x32x16_bf16 v[108:123], v[36:39], v[60:63], v[108:123]
    ds_read_b64_tr_b16 v[80:81], v29 offset:2048
    ds_read_b64_tr_b16 v[82:83], v29 offset:2560
    v_mfma_f32_32x32x16_bf16 v[140:155], v[40:43], v[60:63], v[140:155]
    s_add_u32 m0, s22, 73728
    s_nop 0
    buffer_load_dwordx4 v4, s[8:11], s16 offen lds
    buffer_load_dwordx4 v4, s[8:11], s16 offen offset:1024 lds
    s_cmp_eq_u32 s21, 0
    s_cbranch_scc0 L_g1_d_13
    s_add_u32 m0, s23, 90112
    s_nop 0
    buffer_load_dwordx4 v5, s[64:67], s90 offen lds
    s_add_u32 m0, s23, 94208
    s_nop 0
    buffer_load_dwordx4 v6, s[68:71], s91 offen lds
    s_add_u32 m0, s23, 98304
    s_nop 0
    buffer_load_dwordx4 v7, s[72:75], s92 offen lds
    s_branch L_g1_e_14
L_g1_d_13:
    s_add_u32 m0, s23, 102400
    s_nop 0
    buffer_load_dwordx4 v8, s[76:79], s93 offen lds
    s_add_u32 m0, s23, 106496
    s_nop 0
    buffer_load_dwordx4 v9, s[80:83], s94 offen lds
L_g1_e_14:
    s_add_u32 s16, s16, 16384
    s_add_u32 s90, s90, s95
    s_add_u32 s91, s91, s96
    s_add_u32 s92, s92, s97
    s_add_u32 s93, s93, s98
    s_add_u32 s94, s94, s99
    v_mfma_f32_32x32x16_bf16 v[172:187], v[44:47], v[60:63], v[172:187]
    v_mfma_f32_32x32x16_bf16 v[204:219], v[48:51], v[60:63], v[204:219]
    v_mfma_f32_32x32x16_bf16 v[236:251], v[52:55], v[60:63], v[236:251]
    s_waitcnt lgkmcnt(0)
    v_mfma_f32_32x32x16_bf16 v[92:107], v[64:67], v[84:87], v[92:107]
    ds_read_b128 v[56:59], v10 offset:0
    ds_read_b128 v[60:63], v10 offset:2048
    v_mfma_f32_32x32x16_bf16 v[124:139], v[68:71], v[84:87], v[124:139]
    ds_read_b64_tr_b16 v[36:37], v18 offset:0
    ds_read_b64_tr_b16 v[38:39], v18 offset:512
    v_mfma_f32_32x32x16_bf16 v[156:171], v[72:75], v[84:87], v[156:171]
    ds_read_b64_tr_b16 v[40:41], v19 offset:0
    ds_read_b64_tr_b16 v[42:43], v19 offset:512
    v_mfma_f32_32x32x16_bf16 v[188:203], v[76:79], v[84:87], v[188:203]
    ds_read_b64_tr_b16 v[44:45], v18 offset:4096
    ds_read_b64_tr_b16 v[46:47], v18 offset:4608
    v_mfma_f32_32x32x16_bf16 v[220:235], v[80:83], v[84:87], v[220:235]
    ds_read_b64_tr_b16 v[48:49], v19 offset:4096
    ds_read_b64_tr_b16 v[50:51], v19 offset:4608
    v_mfma_f32_32x32x16_bf16 v[108:123], v[64:67], v[88:91], v[108:123]
    ds_read_b64_tr_b16 v[52:53], v20 offset:0
    ds_read_b64_tr_b16 v[54:55], v20 offset:512
    v_mfma_f32_32x32x16_bf16 v[140:155], v[68:71], v[88:91], v[140:155]
    v_mfma_f32_32x32x16_bf16 v[172:187], v[72:75], v[88:91], v[172:187]
    v_mfma_f32_32x32x16_bf16 v[204:219], v[76:79], v[88:91], v[204:219]
    v_mfma_f32_32x32x16_bf16 v[236:251], v[80:83], v[88:91], v[236:251]
    s_waitcnt vmcnt(4)
    s_barrier
    s_sub_u32 s37, s37, 1
    s_cmp_lg_u32 s37, 0
    s_cbranch_scc1 L_g1_loop
    s_waitcnt lgkmcnt(0)
    v_mfma_f32_32x32x16_bf16 v[92:107], v[36:39], v[56:59], v[92:107]
    ds_read_b128 v[84:87], v11 offset:0
    ds_read_b128 v[88:91], v11 offset:2048
    v_mfma_f32_32x32x16_bf16 v[124:139], v[40:43], v[56:59], v[124:139]
    ds_read_b64_tr_b16 v[64:65], v18 offset:2048
    ds_read_b64_tr_b16 v[66:67], v18 offset:2560
    v_mfma_f32_32x32x16_bf16 v[156:171], v[44:47], v[56:59], v[156:171]
    ds_read_b64_tr_b16 v[68:69], v19 offset:2048
    ds_read_b64_tr_b16 v[70:71], v19 offset:2560
    v_mfma_f32_32x32x16_bf16 v[188:203], v[48:51], v[56:59], v[188:203]
    ds_read_b64_tr_b16 v[72:73], v18 offset:6144
    ds_read_b64_tr_b16 v[74:75], v18 offset:6656
    v_mfma_f32_32x32x16_bf16 v[220:235], v[52:55], v[56:59], v[220:235]
    ds_read_b64_tr_b16 v[76:77], v19 offset:6144
    ds_read_b64_tr_b16 v[78:79], v19 offset:6656
    v_mfma_f32_32x32x16_bf16 v[108:123], v[36:39], v[60:63], v[108:123]
    ds_read_b64_tr_b16 v[80:81], v20 offset:2048
    ds_read_b64_tr_b16 v[82:83], v20 offset:2560
    v_mfma_f32_32x32x16_bf16 v[140:155], v[40:43], v[60:63], v[140:155]
    s_add_u32 m0, s22, 110592
    s_nop 0
    buffer_load_dwordx4 v4, s[8:11], s16 offen lds
    buffer_load_dwordx4 v4, s[8:11], s16 offen offset:1024 lds
    s_cmp_eq_u32 s21, 1
    s_cbranch_scc0 L_g1_d_15
    s_add_u32 m0, s23, 126976
    s_nop 0
    buffer_load_dwordx4 v5, s[64:67], s90 offen lds
    s_add_u32 m0, s23, 131072
    s_nop 0
    buffer_load_dwordx4 v6, s[68:71], s91 offen lds
    s_add_u32 m0, s23, 135168
    s_nop 0
    buffer_load_dwordx4 v7, s[72:75], s92 offen lds
    s_branch L_g1_e_16
L_g1_d_15:
    s_add_u32 m0, s23, 139264
    s_nop 0
    buffer_load_dwordx4 v8, s[76:79], s93 offen lds
    s_add_u32 m0, s23, 143360
    s_nop 0
    buffer_load_dwordx4 v9, s[80:83], s94 offen lds
L_g1_e_16:
    s_add_u32 s16, s16, 16384
    s_add_u32 s90, s90, s95
    s_add_u32 s91, s91, s96
    s_add_u32 s92, s92, s97
    s_add_u32 s93, s93, s98
    s_add_u32 s94, s94, s99
    v_mfma_f32_32x32x16_bf16 v[172:187], v[44:47], v[60:63], v[172:187]
    v_mfma_f32_32x32x16_bf16 v[204:219], v[48:51], v[60:63], v[204:219]
    v_mfma_f32_32x32x16_bf16 v[236:251], v[52:55], v[60:63], v[236:251]
    s_waitcnt lgkmcnt(0)
    v_mfma_f32_32x32x16_bf16 v[92:107], v[64:67], v[84:87], v[92:107]
    ds_read_b128 v[56:59], v12 offset:0
    ds_read_b128 v[60:63], v12 offset:2048
    v_mfma_f32_32x32x16_bf16 v[124:139], v[68:71], v[84:87], v[124:139]
    ds_read_b64_tr_b16 v[36:37], v21 offset:0
    ds_read_b64_tr_b16 v[38:39], v21 offset:512
    v_mfma_f32_32x32x16_bf16 v[156:171], v[72:75], v[84:87], v[156:171]
    ds_read_b64_tr_b16 v[40:41], v22 offset:0
    ds_read_b64_tr_b16 v[42:43], v22 offset:512
    v_mfma_f32_32x32x16_bf16 v[188:203], v[76:79], v[84:87], v[188:203]
    ds_read_b64_tr_b16 v[44:45], v21 offset:4096
    ds_read_b64_tr_b16 v[46:47], v21 offset:4608
    v_mfma_f32_32x32x16_bf16 v[220:235], v[80:83], v[84:87], v[220:235]
    ds_read_b64_tr_b16 v[48:49], v22 offset:4096
    ds_read_b64_tr_b16 v[50:51], v22 offset:4608
    v_mfma_f32_32x32x16_bf16 v[108:123], v[64:67], v[88:91], v[108:123]
    ds_read_b64_tr_b16 v[52:53], v23 offset:0
    ds_read_b64_tr_b16 v[54:55], v23 offset:512
    v_mfma_f32_32x32x16_bf16 v[140:155], v[68:71], v[88:91], v[140:155]
    v_mfma_f32_32x32x16_bf16 v[172:187], v[72:75], v[88:91], v[172:187]
    v_mfma_f32_32x32x16_bf16 v[204:219], v[76:79], v[88:91], v[204:219]
    v_mfma_f32_32x32x16_bf16 v[236:251], v[80:83], v[88:91], v[236:251]
    s_waitcnt vmcnt(4)
    s_barrier
    s_waitcnt lgkmcnt(0)
    v_mfma_f32_32x32x16_bf16 v[92:107], v[36:39], v[56:59], v[92:107]
    ds_read_b128 v[84:87], v13 offset:0
    ds_read_b128 v[88:91], v13 offset:2048
    v_mfma_f32_32x32x16_bf16 v[124:139], v[40:43], v[56:59], v[124:139]
    ds_read_b64_tr_b16 v[64:65], v21 offset:2048
    ds_read_b64_tr_b16 v[66:67], v21 offset:2560
    v_mfma_f32_32x32x16_bf16 v[156:171], v[44:47], v[56:59], v[156:171]
    ds_read_b64_tr_b16 v[68:69], v22 offset:2048
    ds_read_b64_tr_b16 v[70:71], v22 offset:2560
    v_mfma_f32_32x32x16_bf16 v[188:203], v[48:51], v[56:59], v[188:203]
    ds_read_b64_tr_b16 v[72:73], v21 offset:6144
    ds_read_b64_tr_b16 v[74:75], v21 offset:6656
    v_mfma_f32_32x32x16_bf16 v[220:235], v[52:55], v[56:59], v[220:235]
    ds_read_b64_tr_b16 v[76:77], v22 offset:6144
    ds_read_b64_tr_b16 v[78:79], v22 offset:6656
    v_mfma_f32_32x32x16_bf16 v[108:123], v[36:39], v[60:63], v[108:123]
    ds_read_b64_tr_b16 v[80:81], v23 offset:2048
    ds_read_b64_tr_b16 v[82:83], v23 offset:2560
    v_mfma_f32_32x32x16_bf16 v[140:155], v[40:43], v[60:63], v[140:155]
    v_mfma_f32_32x32x16_bf16 v[172:187], v[44:47], v[60:63], v[172:187]
    v_mfma_f32_32x32x16_bf16 v[204:219], v[48:51], v[60:63], v[204:219]
    v_mfma_f32_32x32x16_bf16 v[236:251], v[52:55], v[60:63], v[236:251]
    s_waitcnt lgkmcnt(0)
    v_mfma_f32_32x32x16_bf16 v[92:107], v[64:67], v[84:87], v[92:107]
    ds_read_b128 v[56:59], v14 offset:0
    ds_read_b128 v[60:63], v14 offset:2048
    v_mfma_f32_32x32x16_bf16 v[124:139], v[68:71], v[84:87], v[124:139]
    ds_read_b64_tr_b16 v[36:37], v24 offset:0
    ds_read_b64_tr_b16 v[38:39], v24 offset:512
    v_mfma_f32_32x32x16_bf16 v[156:171], v[72:75], v[84:87], v[156:171]
    ds_read_b64_tr_b16 v[40:41], v25 offset:0
    ds_read_b64_tr_b16 v[42:43], v25 offset:512
    v_mfma_f32_32x32x16_bf16 v[188:203], v[76:79], v[84:87], v[188:203]
    ds_read_b64_tr_b16 v[44:45], v24 offset:4096
    ds_read_b64_tr_b16 v[46:47], v24 offset:4608
    v_mfma_f32_32x32x16_bf16 v[220:235], v[80:83], v[84:87], v[220:235]
    ds_read_b64_tr_b16 v[48:49], v25 offset:4096
    ds_read_b64_tr_b16 v[50:51], v25 offset:4608
    v_mfma_f32_32x32x16_bf16 v[108:123], v[64:67], v[88:91], v[108:123]
    ds_read_b64_tr_b16 v[52:53], v26 offset:0
    ds_read_b64_tr_b16 v[54:55], v26 offset:512
    v_mfma_f32_32x32x16_bf16 v[140:155], v[68:71], v[88:91], v[140:155]
    v_mfma_f32_32x32x16_bf16 v[172:187], v[72:75], v[88:91], v[172:187]
    v_mfma_f32_32x32x16_bf16 v[204:219], v[76:79], v[88:91], v[204:219]
    v_mfma_f32_32x32x16_bf16 v[236:251], v[80:83], v[88:91], v[236:251]
    s_waitcnt vmcnt(0)
    s_barrier
    s_waitcnt lgkmcnt(0)
    v_mfma_f32_32x32x16_bf16 v[92:107], v[36:39], v[56:59], v[92:107]
    ds_read_b128 v[84:87], v15 offset:0
    ds_read_b128 v[88:91], v15 offset:2048
    v_mfma_f32_32x32x16_bf16 v[124:139], v[40:43], v[56:59], v[124:139]
    ds_read_b64_tr_b16 v[64:65], v24 offset:2048
    ds_read_b64_tr_b16 v[66:67], v24 offset:2560
    v_mfma_f32_32x32x16_bf16 v[156:171], v[44:47], v[56:59], v[156:171]
    ds_read_b64_tr_b16 v[68:69], v25 offset:2048
    ds_read_b64_tr_b16 v[70:71], v25 offset:2560
    v_mfma_f32_32x32x16_bf16 v[188:203], v[48:51], v[56:59], v[188:203]
    ds_read_b64_tr_b16 v[72:73], v24 offset:6144
    ds_read_b64_tr_b16 v[74:75], v24 offset:6656
    v_mfma_f32_32x32x16_bf16 v[220:235], v[52:55], v[56:59], v[220:235]
    ds_read_b64_tr_b16 v[76:77], v25 offset:6144
    ds_read_b64_tr_b16 v[78:79], v25 offset:6656
    v_mfma_f32_32x32x16_bf16 v[108:123], v[36:39], v[60:63], v[108:123]
    ds_read_b64_tr_b16 v[80:81], v26 offset:2048
    ds_read_b64_tr_b16 v[82:83], v26 offset:2560
    v_mfma_f32_32x32x16_bf16 v[140:155], v[40:43], v[60:63], v[140:155]
    v_mfma_f32_32x32x16_bf16 v[172:187], v[44:47], v[60:63], v[172:187]
    v_mfma_f32_32x32x16_bf16 v[204:219], v[48:51], v[60:63], v[204:219]
    v_mfma_f32_32x32x16_bf16 v[236:251], v[52:55], v[60:63], v[236:251]
    s_waitcnt lgkmcnt(0)
    v_mfma_f32_32x32x16_bf16 v[92:107], v[64:67], v[84:87], v[92:107]
    ds_read_b128 v[56:59], v16 offset:0
    ds_read_b128 v[60:63], v16 offset:2048
    v_mfma_f32_32x32x16_bf16 v[124:139], v[68:71], v[84:87], v[124:139]
    ds_read_b64_tr_b16 v[36:37], v27 offset:0
    ds_read_b64_tr_b16 v[38:39], v27 offset:512
    v_mfma_f32_32x32x16_bf16 v[156:171], v[72:75], v[84:87], v[156:171]
    ds_read_b64_tr_b16 v[40:41], v28 offset:0
    ds_read_b64_tr_b16 v[42:43], v28 offset:512
    v_mfma_f32_32x32x16_bf16 v[188:203], v[76:79], v[84:87], v[188:203]
    ds_read_b64_tr_b16 v[44:45], v27 offset:4096
    ds_read_b64_tr_b16 v[46:47], v27 offset:4608
    v_mfma_f32_32x32x16_bf16 v[220:235], v[80:83], v[84:87], v[220:235]
    ds_read_b64_tr_b16 v[48:49], v28 offset:4096
    ds_read_b64_tr_b16 v[50:51], v28 offset:4608
    v_mfma_f32_32x32x16_bf16 v[108:123], v[64:67], v[88:91], v[108:123]
    ds_read_b64_tr_b16 v[52:53], v29 offset:0
    ds_read_b64_tr_b16 v[54:55], v29 offset:512
    v_mfma_f32_32x32x16_bf16 v[140:155], v[68:71], v[88:91], v[140:155]
    v_mfma_f32_32x32x16_bf16 v[172:187], v[72:75], v[88:91], v[172:187]
    v_mfma_f32_32x32x16_bf16 v[204:219], v[76:79], v[88:91], v[204:219]
    v_mfma_f32_32x32x16_bf16 v[236:251], v[80:83], v[88:91], v[236:251]
    s_barrier
    s_waitcnt lgkmcnt(0)
    v_mfma_f32_32x32x16_bf16 v[92:107], v[36:39], v[56:59], v[92:107]
    ds_read_b128 v[84:87], v17 offset:0
    ds_read_b128 v[88:91], v17 offset:2048
    v_mfma_f32_32x32x16_bf16 v[124:139], v[40:43], v[56:59], v[124:139]
    ds_read_b64_tr_b16 v[64:65], v27 offset:2048
    ds_read_b64_tr_b16 v[66:67], v27 offset:2560
    v_mfma_f32_32x32x16_bf16 v[156:171], v[44:47], v[56:59], v[156:171]
    ds_read_b64_tr_b16 v[68:69], v28 offset:2048
    ds_read_b64_tr_b16 v[70:71], v28 offset:2560
    v_mfma_f32_32x32x16_bf16 v[188:203], v[48:51], v[56:59], v[188:203]
    ds_read_b64_tr_b16 v[72:73], v27 offset:6144
    ds_read_b64_tr_b16 v[74:75], v27 offset:6656
    v_mfma_f32_32x32x16_bf16 v[220:235], v[52:55], v[56:59], v[220:235]
    ds_read_b64_tr_b16 v[76:77], v28 offset:6144
    ds_read_b64_tr_b16 v[78:79], v28 offset:6656
    v_mfma_f32_32x32x16_bf16 v[108:123], v[36:39], v[60:63], v[108:123]
    ds_read_b64_tr_b16 v[80:81], v29 offset:2048
    ds_read_b64_tr_b16 v[82:83], v29 offset:2560
    v_mfma_f32_32x32x16_bf16 v[140:155], v[40:43], v[60:63], v[140:155]
    v_mfma_f32_32x32x16_bf16 v[172:187], v[44:47], v[60:63], v[172:187]
    v_mfma_f32_32x32x16_bf16 v[204:219], v[48:51], v[60:63], v[204:219]
    v_mfma_f32_32x32x16_bf16 v[236:251], v[52:55], v[60:63], v[236:251]
    s_waitcnt lgkmcnt(0)
    v_mfma_f32_32x32x16_bf16 v[92:107], v[64:67], v[84:87], v[92:107]
    v_mfma_f32_32x32x16_bf16 v[124:139], v[68:71], v[84:87], v[124:139]
    v_mfma_f32_32x32x16_bf16 v[156:171], v[72:75], v[84:87], v[156:171]
    v_mfma_f32_32x32x16_bf16 v[188:203], v[76:79], v[84:87], v[188:203]
    v_mfma_f32_32x32x16_bf16 v[220:235], v[80:83], v[84:87], v[220:235]
    v_mfma_f32_32x32x16_bf16 v[108:123], v[64:67], v[88:91], v[108:123]
    v_mfma_f32_32x32x16_bf16 v[140:155], v[68:71], v[88:91], v[140:155]
    v_mfma_f32_32x32x16_bf16 v[172:187], v[72:75], v[88:91], v[172:187]
    v_mfma_f32_32x32x16_bf16 v[204:219], v[76:79], v[88:91], v[204:219]
    v_mfma_f32_32x32x16_bf16 v[236:251], v[80:83], v[88:91], v[236:251]
    s_nop 15
    s_nop 7
    s_barrier
    v_and_b32 v30, 31, v2
    v_lshrrev_b32 v31, 5, v2
    v_lshlrev_b32 v4, 6, v30
    v_lshl_add_u32 v4, v31, 3, v4
    s_lshl_b32 s35, s20, 13
    v_add_u32 v4, s35, v4
    v_bfe_u32 v32, v30, 2, 2
    v_xor_b32 v33, 0, v32
    v_lshl_add_u32 v5, v33, 4, v4
    v_xor_b32 v33, 1, v32
    v_lshl_add_u32 v6, v33, 4, v4
    v_xor_b32 v33, 2, v32
    v_lshl_add_u32 v7, v33, 4, v4
    v_xor_b32 v33, 3, v32
    v_lshl_add_u32 v8, v33, 4, v4
    v_lshlrev_b32 v9, 4, v2
    v_add_u32 v10, s35, v9
    s_add_u32 s8, s26, 4194304
    s_addc_u32 s9, s27, 0
    s_mov_b32 s10, 12582912
    s_add_u32 s12, s26, 16777216
    s_addc_u32 s13, s27, 0
    s_mov_b32 s14, 18874368
    s_mov_b32 s15, 0x00020000
    s_lshr_b32 s35, s20, 1
    s_lshl_b32 s39, s35, 12
    s_and_b32 s38, s20, 1
    s_cmp_lt_u32 s31, 28
    s_cbranch_scc0 L_g1_epiB
    s_mul_i32 s35, s30, 144
    s_lshl_b32 s36, s31, 2
    s_add_u32 s35, s35, s36
    s_lshl_b32 s36, s38, 1
    s_add_u32 s35, s35, s36
    s_add_u32 s35, s35, 32
    s_lshl_b32 s35, s35, 14
    s_add_u32 s35, s35, s39
    v_cvt_pk_bf16_f32 v32, v92, v93
    v_cvt_pk_bf16_f32 v33, v94, v95
    v_cvt_pk_bf16_f32 v34, v156, v157
    v_cvt_pk_bf16_f32 v35, v158, v159
    v_lshlrev_b32 v92, 16, v32
    v_and_b32 v93, 0xffff0000, v32
    v_lshlrev_b32 v94, 16, v33
    v_and_b32 v95, 0xffff0000, v33
    v_lshlrev_b32 v156, 16, v34
    v_and_b32 v157, 0xffff0000, v34
    v_lshlrev_b32 v158, 16, v35
    v_and_b32 v159, 0xffff0000, v35
    v_max_f32 v92, 0, v92
    v_max_f32 v93, 0, v93
    v_max_f32 v94, 0, v94
    v_max_f32 v95, 0, v95
    v_mul_f32 v92, v92, v156
    v_mul_f32 v93, v93, v157
    v_mul_f32 v94, v94, v158
    v_mul_f32 v95, v95, v159
    v_cvt_pk_bf16_f32 v32, v92, v93
    v_cvt_pk_bf16_f32 v33, v94, v95
    ds_write_b64 v5, v[32:33] offset:0
    v_cvt_pk_bf16_f32 v32, v96, v97
    v_cvt_pk_bf16_f32 v33, v98, v99
    v_cvt_pk_bf16_f32 v34, v160, v161
    v_cvt_pk_bf16_f32 v35, v162, v163
    v_lshlrev_b32 v96, 16, v32
    v_and_b32 v97, 0xffff0000, v32
    v_lshlrev_b32 v98, 16, v33
    v_and_b32 v99, 0xffff0000, v33
    v_lshlrev_b32 v160, 16, v34
    v_and_b32 v161, 0xffff0000, v34
    v_lshlrev_b32 v162, 16, v35
    v_and_b32 v163, 0xffff0000, v35
    v_max_f32 v96, 0, v96
    v_max_f32 v97, 0, v97
    v_max_f32 v98, 0, v98
    v_max_f32 v99, 0, v99
    v_mul_f32 v96, v96, v160
    v_mul_f32 v97, v97, v161
    v_mul_f32 v98, v98, v162
    v_mul_f32 v99, v99, v163
    v_cvt_pk_bf16_f32 v32, v96, v97
    v_cvt_pk_bf16_f32 v33, v98, v99
    ds_write_b64 v6, v[32:33] offset:0
    v_cvt_pk_bf16_f32 v32, v100, v101
    v_cvt_pk_bf16_f32 v33, v102, v103
    v_cvt_pk_bf16_f32 v34, v164, v165
    v_cvt_pk_bf16_f32 v35, v166, v167
    v_lshlrev_b32 v100, 16, v32
    v_and_b32 v101, 0xffff0000, v32
    v_lshlrev_b32 v102, 16, v33
    v_and_b32 v103, 0xffff0000, v33
    v_lshlrev_b32 v164, 16, v34
    v_and_b32 v165, 0xffff0000, v34
    v_lshlrev_b32 v166, 16, v35
    v_and_b32 v167, 0xffff0000, v35
    v_max_f32 v100, 0, v100
    v_max_f32 v101, 0, v101
    v_max_f32 v102, 0, v102
    v_max_f32 v103, 0, v103
    v_mul_f32 v100, v100, v164
    v_mul_f32 v101, v101, v165
    v_mul_f32 v102, v102, v166
    v_mul_f32 v103, v103, v167
    v_cvt_pk_bf16_f32 v32, v100, v101
    v_cvt_pk_bf16_f32 v33, v102, v103
    ds_write_b64 v7, v[32:33] offset:0
    v_cvt_pk_bf16_f32 v32, v104, v105
    v_cvt_pk_bf16_f32 v33, v106, v107
    v_cvt_pk_bf16_f32 v34, v168, v169
    v_cvt_pk_bf16_f32 v35, v170, v171
    v_lshlrev_b32 v104, 16, v32
    v_and_b32 v105, 0xffff0000, v32
    v_lshlrev_b32 v106, 16, v33
    v_and_b32 v107, 0xffff0000, v33
    v_lshlrev_b32 v168, 16, v34
    v_and_b32 v169, 0xffff0000, v34
    v_lshlrev_b32 v170, 16, v35
    v_and_b32 v171, 0xffff0000, v35
    v_max_f32 v104, 0, v104
    v_max_f32 v105, 0, v105
    v_max_f32 v106, 0, v106
    v_max_f32 v107, 0, v107
    v_mul_f32 v104, v104, v168
    v_mul_f32 v105, v105, v169
    v_mul_f32 v106, v106, v170
    v_mul_f32 v107, v107, v171
    v_cvt_pk_bf16_f32 v32, v104, v105
    v_cvt_pk_bf16_f32 v33, v106, v107
    ds_write_b64 v8, v[32:33] offset:0
    v_cvt_pk_bf16_f32 v32, v108, v109
    v_cvt_pk_bf16_f32 v33, v110, v111
    v_cvt_pk_bf16_f32 v34, v172, v173
    v_cvt_pk_bf16_f32 v35, v174, v175
    v_lshlrev_b32 v108, 16, v32
    v_and_b32 v109, 0xffff0000, v32
    v_lshlrev_b32 v110, 16, v33
    v_and_b32 v111, 0xffff0000, v33
    v_lshlrev_b32 v172, 16, v34
    v_and_b32 v173, 0xffff0000, v34
    v_lshlrev_b32 v174, 16, v35
    v_and_b32 v175, 0xffff0000, v35
    v_max_f32 v108, 0, v108
    v_max_f32 v109, 0, v109
    v_max_f32 v110, 0, v110
    v_max_f32 v111, 0, v111
    v_mul_f32 v108, v108, v172
    v_mul_f32 v109, v109, v173
    v_mul_f32 v110, v110, v174
    v_mul_f32 v111, v111, v175
    v_cvt_pk_bf16_f32 v32, v108, v109
    v_cvt_pk_bf16_f32 v33, v110, v111
    ds_write_b64 v5, v[32:33] offset:2048
    v_cvt_pk_bf16_f32 v32, v112, v113
    v_cvt_pk_bf16_f32 v33, v114, v115
    v_cvt_pk_bf16_f32 v34, v176, v177
    v_cvt_pk_bf16_f32 v35, v178, v179
    v_lshlrev_b32 v112, 16, v32
    v_and_b32 v113, 0xffff0000, v32
    v_lshlrev_b32 v114, 16, v33
    v_and_b32 v115, 0xffff0000, v33
    v_lshlrev_b32 v176, 16, v34
    v_and_b32 v177, 0xffff0000, v34
    v_lshlrev_b32 v178, 16, v35
    v_and_b32 v179, 0xffff0000, v35
    v_max_f32 v112, 0, v112
    v_max_f32 v113, 0, v113
    v_max_f32 v114, 0, v114
    v_max_f32 v115, 0, v115
    v_mul_f32 v112, v112, v176
    v_mul_f32 v113, v113, v177
    v_mul_f32 v114, v114, v178
    v_mul_f32 v115, v115, v179
    v_cvt_pk_bf16_f32 v32, v112, v113
    v_cvt_pk_bf16_f32 v33, v114, v115
    ds_write_b64 v6, v[32:33] offset:2048
    v_cvt_pk_bf16_f32 v32, v116, v117
    v_cvt_pk_bf16_f32 v33, v118, v119
    v_cvt_pk_bf16_f32 v34, v180, v181
    v_cvt_pk_bf16_f32 v35, v182, v183
    v_lshlrev_b32 v116, 16, v32
    v_and_b32 v117, 0xffff0000, v32
    v_lshlrev_b32 v118, 16, v33
    v_and_b32 v119, 0xffff0000, v33
    v_lshlrev_b32 v180, 16, v34
    v_and_b32 v181, 0xffff0000, v34
    v_lshlrev_b32 v182, 16, v35
    v_and_b32 v183, 0xffff0000, v35
    v_max_f32 v116, 0, v116
    v_max_f32 v117, 0, v117
    v_max_f32 v118, 0, v118
    v_max_f32 v119, 0, v119
    v_mul_f32 v116, v116, v180
    v_mul_f32 v117, v117, v181
    v_mul_f32 v118, v118, v182
    v_mul_f32 v119, v119, v183
    v_cvt_pk_bf16_f32 v32, v116, v117
    v_cvt_pk_bf16_f32 v33, v118, v119
    ds_write_b64 v7, v[32:33] offset:2048
    v_cvt_pk_bf16_f32 v32, v120, v121
    v_cvt_pk_bf16_f32 v33, v122, v123
    v_cvt_pk_bf16_f32 v34, v184, v185
    v_cvt_pk_bf16_f32 v35, v186, v187
    v_lshlrev_b32 v120, 16, v32
    v_and_b32 v121, 0xffff0000, v32
    v_lshlrev_b32 v122, 16, v33
    v_and_b32 v123, 0xffff0000, v33
    v_lshlrev_b32 v184, 16, v34
    v_and_b32 v185, 0xffff0000, v34
    v_lshlrev_b32 v186, 16, v35
    v_and_b32 v187, 0xffff0000, v35
    v_max_f32 v120, 0, v120
    v_max_f32 v121, 0, v121
    v_max_f32 v122, 0, v122
    v_max_f32 v123, 0, v123
    v_mul_f32 v120, v120, v184
    v_mul_f32 v121, v121, v185
    v_mul_f32 v122, v122, v186
    v_mul_f32 v123, v123, v187
    v_cvt_pk_bf16_f32 v32, v120, v121
    v_cvt_pk_bf16_f32 v33, v122, v123
    ds_write_b64 v8, v[32:33] offset:2048
    s_waitcnt lgkmcnt(0)
    ds_read_b128 v[36:39], v10 offset:0
    ds_read_b128 v[40:43], v10 offset:1024
    ds_read_b128 v[44:47], v10 offset:2048
    ds_read_b128 v[48:51], v10 offset:3072
    s_waitcnt lgkmcnt(0)
    buffer_store_dwordx4 v[36:39], v9, s[12:15], s35 offen offset:0
    buffer_store_dwordx4 v[40:43], v9, s[12:15], s35 offen offset:1024
    buffer_store_dwordx4 v[44:47], v9, s[12:15], s35 offen offset:2048
    buffer_store_dwordx4 v[48:51], v9, s[12:15], s35 offen offset:3072
    s_add_u32 s36, s35, 16384
    v_cvt_pk_bf16_f32 v32, v124, v125
    v_cvt_pk_bf16_f32 v33, v126, v127
    v_cvt_pk_bf16_f32 v34, v188, v189
    v_cvt_pk_bf16_f32 v35, v190, v191
    v_lshlrev_b32 v124, 16, v32
    v_and_b32 v125, 0xffff0000, v32
    v_lshlrev_b32 v126, 16, v33
    v_and_b32 v127, 0xffff0000, v33
    v_lshlrev_b32 v188, 16, v34
    v_and_b32 v189, 0xffff0000, v34
    v_lshlrev_b32 v190, 16, v35
    v_and_b32 v191, 0xffff0000, v35
    v_max_f32 v124, 0, v124
    v_max_f32 v125, 0, v125
    v_max_f32 v126, 0, v126
    v_max_f32 v127, 0, v127
    v_mul_f32 v124, v124, v188
    v_mul_f32 v125, v125, v189
    v_mul_f32 v126, v126, v190
    v_mul_f32 v127, v127, v191
    v_cvt_pk_bf16_f32 v32, v124, v125
    v_cvt_pk_bf16_f32 v33, v126, v127
    ds_write_b64 v5, v[32:33] offset:4096
    v_cvt_pk_bf16_f32 v32, v128, v129
    v_cvt_pk_bf16_f32 v33, v130, v131
    v_cvt_pk_bf16_f32 v34, v192, v193
    v_cvt_pk_bf16_f32 v35, v194, v195
    v_lshlrev_b32 v128, 16, v32
    v_and_b32 v129, 0xffff0000, v32
    v_lshlrev_b32 v130, 16, v33
    v_and_b32 v131, 0xffff0000, v33
    v_lshlrev_b32 v192, 16, v34
    v_and_b32 v193, 0xffff0000, v34
    v_lshlrev_b32 v194, 16, v35
    v_and_b32 v195, 0xffff0000, v35
    v_max_f32 v128, 0, v128
    v_max_f32 v129, 0, v129
    v_max_f32 v130, 0, v130
    v_max_f32 v131, 0, v131
    v_mul_f32 v128, v128, v192
    v_mul_f32 v129, v129, v193
    v_mul_f32 v130, v130, v194
    v_mul_f32 v131, v131, v195
    v_cvt_pk_bf16_f32 v32, v128, v129
    v_cvt_pk_bf16_f32 v33, v130, v131
    ds_write_b64 v6, v[32:33] offset:4096
    v_cvt_pk_bf16_f32 v32, v132, v133
    v_cvt_pk_bf16_f32 v33, v134, v135
    v_cvt_pk_bf16_f32 v34, v196, v197
    v_cvt_pk_bf16_f32 v35, v198, v199
    v_lshlrev_b32 v132, 16, v32
    v_and_b32 v133, 0xffff0000, v32
    v_lshlrev_b32 v134, 16, v33
    v_and_b32 v135, 0xffff0000, v33
    v_lshlrev_b32 v196, 16, v34
    v_and_b32 v197, 0xffff0000, v34
    v_lshlrev_b32 v198, 16, v35
    v_and_b32 v199, 0xffff0000, v35
    v_max_f32 v132, 0, v132
    v_max_f32 v133, 0, v133
    v_max_f32 v134, 0, v134
    v_max_f32 v135, 0, v135
    v_mul_f32 v132, v132, v196
    v_mul_f32 v133, v133, v197
    v_mul_f32 v134, v134, v198
    v_mul_f32 v135, v135, v199
    v_cvt_pk_bf16_f32 v32, v132, v133
    v_cvt_pk_bf16_f32 v33, v134, v135
    ds_write_b64 v7, v[32:33] offset:4096
    v_cvt_pk_bf16_f32 v32, v136, v137
    v_cvt_pk_bf16_f32 v33, v138, v139
    v_cvt_pk_bf16_f32 v34, v200, v201
    v_cvt_pk_bf16_f32 v35, v202, v203
    v_lshlrev_b32 v136, 16, v32
    v_and_b32 v137, 0xffff0000, v32
    v_lshlrev_b32 v138, 16, v33
    v_and_b32 v139, 0xffff0000, v33
    v_lshlrev_b32 v200, 16, v34
    v_and_b32 v201, 0xffff0000, v34
    v_lshlrev_b32 v202, 16, v35
    v_and_b32 v203, 0xffff0000, v35
    v_max_f32 v136, 0, v136
    v_max_f32 v137, 0, v137
    v_max_f32 v138, 0, v138
    v_max_f32 v139, 0, v139
    v_mul_f32 v136, v136, v200
    v_mul_f32 v137, v137, v201
    v_mul_f32 v138, v138, v202
    v_mul_f32 v139, v139, v203
    v_cvt_pk_bf16_f32 v32, v136, v137
    v_cvt_pk_bf16_f32 v33, v138, v139
    ds_write_b64 v8, v[32:33] offset:4096
    v_cvt_pk_bf16_f32 v32, v140, v141
    v_cvt_pk_bf16_f32 v33, v142, v143
    v_cvt_pk_bf16_f32 v34, v204, v205
    v_cvt_pk_bf16_f32 v35, v206, v207
    v_lshlrev_b32 v140, 16, v32
    v_and_b32 v141, 0xffff0000, v32
    v_lshlrev_b32 v142, 16, v33
    v_and_b32 v143, 0xffff0000, v33
    v_lshlrev_b32 v204, 16, v34
    v_and_b32 v205, 0xffff0000, v34
    v_lshlrev_b32 v206, 16, v35
    v_and_b32 v207, 0xffff0000, v35
    v_max_f32 v140, 0, v140
    v_max_f32 v141, 0, v141
    v_max_f32 v142, 0, v142
    v_max_f32 v143, 0, v143
    v_mul_f32 v140, v140, v204
    v_mul_f32 v141, v141, v205
    v_mul_f32 v142, v142, v206
    v_mul_f32 v143, v143, v207
    v_cvt_pk_bf16_f32 v32, v140, v141
    v_cvt_pk_bf16_f32 v33, v142, v143
    ds_write_b64 v5, v[32:33] offset:6144
    v_cvt_pk_bf16_f32 v32, v144, v145
    v_cvt_pk_bf16_f32 v33, v146, v147
    v_cvt_pk_bf16_f32 v34, v208, v209
    v_cvt_pk_bf16_f32 v35, v210, v211
    v_lshlrev_b32 v144, 16, v32
    v_and_b32 v145, 0xffff0000, v32
    v_lshlrev_b32 v146, 16, v33
    v_and_b32 v147, 0xffff0000, v33
    v_lshlrev_b32 v208, 16, v34
    v_and_b32 v209, 0xffff0000, v34
    v_lshlrev_b32 v210, 16, v35
    v_and_b32 v211, 0xffff0000, v35
    v_max_f32 v144, 0, v144
    v_max_f32 v145, 0, v145
    v_max_f32 v146, 0, v146
    v_max_f32 v147, 0, v147
    v_mul_f32 v144, v144, v208
    v_mul_f32 v145, v145, v209
    v_mul_f32 v146, v146, v210
    v_mul_f32 v147, v147, v211
    v_cvt_pk_bf16_f32 v32, v144, v145
    v_cvt_pk_bf16_f32 v33, v146, v147
    ds_write_b64 v6, v[32:33] offset:6144
    v_cvt_pk_bf16_f32 v32, v148, v149
    v_cvt_pk_bf16_f32 v33, v150, v151
    v_cvt_pk_bf16_f32 v34, v212, v213
    v_cvt_pk_bf16_f32 v35, v214, v215
    v_lshlrev_b32 v148, 16, v32
    v_and_b32 v149, 0xffff0000, v32
    v_lshlrev_b32 v150, 16, v33
    v_and_b32 v151, 0xffff0000, v33
    v_lshlrev_b32 v212, 16, v34
    v_and_b32 v213, 0xffff0000, v34
    v_lshlrev_b32 v214, 16, v35
    v_and_b32 v215, 0xffff0000, v35
    v_max_f32 v148, 0, v148
    v_max_f32 v149, 0, v149
    v_max_f32 v150, 0, v150
    v_max_f32 v151, 0, v151
    v_mul_f32 v148, v148, v212
    v_mul_f32 v149, v149, v213
    v_mul_f32 v150, v150, v214
    v_mul_f32 v151, v151, v215
    v_cvt_pk_bf16_f32 v32, v148, v149
    v_cvt_pk_bf16_f32 v33, v150, v151
    ds_write_b64 v7, v[32:33] offset:6144
    v_cvt_pk_bf16_f32 v32, v152, v153
    v_cvt_pk_bf16_f32 v33, v154, v155
    v_cvt_pk_bf16_f32 v34, v216, v217
    v_cvt_pk_bf16_f32 v35, v218, v219
    v_lshlrev_b32 v152, 16, v32
    v_and_b32 v153, 0xffff0000, v32
    v_lshlrev_b32 v154, 16, v33
    v_and_b32 v155, 0xffff0000, v33
    v_lshlrev_b32 v216, 16, v34
    v_and_b32 v217, 0xffff0000, v34
    v_lshlrev_b32 v218, 16, v35
    v_and_b32 v219, 0xffff0000, v35
    v_max_f32 v152, 0, v152
    v_max_f32 v153, 0, v153
    v_max_f32 v154, 0, v154
    v_max_f32 v155, 0, v155
    v_mul_f32 v152, v152, v216
    v_mul_f32 v153, v153, v217
    v_mul_f32 v154, v154, v218
    v_mul_f32 v155, v155, v219
    v_cvt_pk_bf16_f32 v32, v152, v153
    v_cvt_pk_bf16_f32 v33, v154, v155
    ds_write_b64 v8, v[32:33] offset:6144
    s_waitcnt lgkmcnt(0)
    ds_read_b128 v[52:55], v10 offset:4096
    ds_read_b128 v[56:59], v10 offset:5120
    ds_read_b128 v[60:63], v10 offset:6144
    ds_read_b128 v[64:67], v10 offset:7168
    s_waitcnt lgkmcnt(0)
    buffer_store_dwordx4 v[52:55], v9, s[12:15], s36 offen offset:0
    buffer_store_dwordx4 v[56:59], v9, s[12:15], s36 offen offset:1024
    buffer_store_dwordx4 v[60:63], v9, s[12:15], s36 offen offset:2048
    buffer_store_dwordx4 v[64:67], v9, s[12:15], s36 offen offset:3072
    s_lshl_b32 s35, s31, 1
    s_add_u32 s35, s35, s38
    s_lshl_b32 s35, s35, 17
    s_lshl_b32 s36, s30, 14
    s_add_u32 s35, s35, s36
    s_add_u32 s35, s35, s39
    v_cvt_pk_bf16_f32 v32, v220, v221
    v_cvt_pk_bf16_f32 v33, v222, v223
    ds_write_b64 v4, v[32:33] offset:0
    v_cvt_pk_bf16_f32 v32, v224, v225
    v_cvt_pk_bf16_f32 v33, v226, v227
    ds_write_b64 v4, v[32:33] offset:16
    v_cvt_pk_bf16_f32 v32, v228, v229
    v_cvt_pk_bf16_f32 v33, v230, v231
    ds_write_b64 v4, v[32:33] offset:32
    v_cvt_pk_bf16_f32 v32, v232, v233
    v_cvt_pk_bf16_f32 v33, v234, v235
    ds_write_b64 v4, v[32:33] offset:48
    v_cvt_pk_bf16_f32 v32, v236, v237
    v_cvt_pk_bf16_f32 v33, v238, v239
    ds_write_b64 v4, v[32:33] offset:2048
    v_cvt_pk_bf16_f32 v32, v240, v241
    v_cvt_pk_bf16_f32 v33, v242, v243
    ds_write_b64 v4, v[32:33] offset:2064
    v_cvt_pk_bf16_f32 v32, v244, v245
    v_cvt_pk_bf16_f32 v33, v246, v247
    ds_write_b64 v4, v[32:33] offset:2080
    v_cvt_pk_bf16_f32 v32, v248, v249
    v_cvt_pk_bf16_f32 v33, v250, v251
    ds_write_b64 v4, v[32:33] offset:2096
    s_waitcnt lgkmcnt(0)
    ds_read_b128 v[36:39], v10 offset:0
    ds_read_b128 v[40:43], v10 offset:1024
    ds_read_b128 v[44:47], v10 offset:2048
    ds_read_b128 v[48:51], v10 offset:3072
    s_waitcnt lgkmcnt(0)
    buffer_store_dwordx4 v[36:39], v9, s[8:11], s35 offen offset:0
    buffer_store_dwordx4 v[40:43], v9, s[8:11], s35 offen offset:1024
    buffer_store_dwordx4 v[44:47], v9, s[8:11], s35 offen offset:2048
    buffer_store_dwordx4 v[48:51], v9, s[8:11], s35 offen offset:3072
    s_branch L_g1_done
L_g1_epiB:
    s_sub_u32 s18, s31, 28
    s_mul_i32 s18, s18, 10
    s_add_u32 s18, s18, 56
    s_lshl_b32 s19, s30, 14
    s_add_u32 s19, s19, s39
    s_lshl_b32 s36, s38, 2
    s_add_u32 s35, s18, s36
    s_add_u32 s35, s35, 0
    s_lshl_b32 s35, s35, 17
    s_add_u32 s35, s35, s19
    v_cvt_pk_bf16_f32 v32, v92, v93
    v_cvt_pk_bf16_f32 v33, v94, v95
    ds_write_b64 v4, v[32:33] offset:0
    v_cvt_pk_bf16_f32 v32, v96, v97
    v_cvt_pk_bf16_f32 v33, v98, v99
    ds_write_b64 v4, v[32:33] offset:16
    v_cvt_pk_bf16_f32 v32, v100, v101
    v_cvt_pk_bf16_f32 v33, v102, v103
    ds_write_b64 v4, v[32:33] offset:32
    v_cvt_pk_bf16_f32 v32, v104, v105
    v_cvt_pk_bf16_f32 v33, v106, v107
    ds_write_b64 v4, v[32:33] offset:48
    v_cvt_pk_bf16_f32 v32, v108, v109
    v_cvt_pk_bf16_f32 v33, v110, v111
    ds_write_b64 v4, v[32:33] offset:2048
    v_cvt_pk_bf16_f32 v32, v112, v113
    v_cvt_pk_bf16_f32 v33, v114, v115
    ds_write_b64 v4, v[32:33] offset:2064
    v_cvt_pk_bf16_f32 v32, v116, v117
    v_cvt_pk_bf16_f32 v33, v118, v119
    ds_write_b64 v4, v[32:33] offset:2080
    v_cvt_pk_bf16_f32 v32, v120, v121
    v_cvt_pk_bf16_f32 v33, v122, v123
    ds_write_b64 v4, v[32:33] offset:2096
    s_waitcnt lgkmcnt(0)
    ds_read_b128 v[52:55], v10 offset:0
    ds_read_b128 v[56:59], v10 offset:1024
    ds_read_b128 v[60:63], v10 offset:2048
    ds_read_b128 v[64:67], v10 offset:3072
    s_waitcnt lgkmcnt(0)
    buffer_store_dwordx4 v[52:55], v9, s[8:11], s35 offen offset:0
    buffer_store_dwordx4 v[56:59], v9, s[8:11], s35 offen offset:1024
    buffer_store_dwordx4 v[60:63], v9, s[8:11], s35 offen offset:2048
    buffer_store_dwordx4 v[64:67], v9, s[8:11], s35 offen offset:3072
    s_lshl_b32 s36, s38, 2
    s_add_u32 s35, s18, s36
    s_add_u32 s35, s35, 1
    s_lshl_b32 s35, s35, 17
    s_add_u32 s35, s35, s19
    v_cvt_pk_bf16_f32 v32, v124, v125
    v_cvt_pk_bf16_f32 v33, v126, v127
    ds_write_b64 v4, v[32:33] offset:4096
    v_cvt_pk_bf16_f32 v32, v128, v129
    v_cvt_pk_bf16_f32 v33, v130, v131
    ds_write_b64 v4, v[32:33] offset:4112
    v_cvt_pk_bf16_f32 v32, v132, v133
    v_cvt_pk_bf16_f32 v33, v134, v135
    ds_write_b64 v4, v[32:33] offset:4128
    v_cvt_pk_bf16_f32 v32, v136, v137
    v_cvt_pk_bf16_f32 v33, v138, v139
    ds_write_b64 v4, v[32:33] offset:4144
    v_cvt_pk_bf16_f32 v32, v140, v141
    v_cvt_pk_bf16_f32 v33, v142, v143
    ds_write_b64 v4, v[32:33] offset:6144
    v_cvt_pk_bf16_f32 v32, v144, v145
    v_cvt_pk_bf16_f32 v33, v146, v147
    ds_write_b64 v4, v[32:33] offset:6160
    v_cvt_pk_bf16_f32 v32, v148, v149
    v_cvt_pk_bf16_f32 v33, v150, v151
    ds_write_b64 v4, v[32:33] offset:6176
    v_cvt_pk_bf16_f32 v32, v152, v153
    v_cvt_pk_bf16_f32 v33, v154, v155
    ds_write_b64 v4, v[32:33] offset:6192
    s_waitcnt lgkmcnt(0)
    ds_read_b128 v[36:39], v10 offset:4096
    ds_read_b128 v[40:43], v10 offset:5120
    ds_read_b128 v[44:47], v10 offset:6144
    ds_read_b128 v[48:51], v10 offset:7168
    s_waitcnt lgkmcnt(0)
    buffer_store_dwordx4 v[36:39], v9, s[8:11], s35 offen offset:0
    buffer_store_dwordx4 v[40:43], v9, s[8:11], s35 offen offset:1024
    buffer_store_dwordx4 v[44:47], v9, s[8:11], s35 offen offset:2048
    buffer_store_dwordx4 v[48:51], v9, s[8:11], s35 offen offset:3072
    s_lshl_b32 s36, s38, 2
    s_add_u32 s35, s18, s36
    s_add_u32 s35, s35, 2
    s_lshl_b32 s35, s35, 17
    s_add_u32 s35, s35, s19
    v_cvt_pk_bf16_f32 v32, v156, v157
    v_cvt_pk_bf16_f32 v33, v158, v159
    ds_write_b64 v4, v[32:33] offset:0
    v_cvt_pk_bf16_f32 v32, v160, v161
    v_cvt_pk_bf16_f32 v33, v162, v163
    ds_write_b64 v4, v[32:33] offset:16
    v_cvt_pk_bf16_f32 v32, v164, v165
    v_cvt_pk_bf16_f32 v33, v166, v167
    ds_write_b64 v4, v[32:33] offset:32
    v_cvt_pk_bf16_f32 v32, v168, v169
    v_cvt_pk_bf16_f32 v33, v170, v171
    ds_write_b64 v4, v[32:33] offset:48
    v_cvt_pk_bf16_f32 v32, v172, v173
    v_cvt_pk_bf16_f32 v33, v174, v175
    ds_write_b64 v4, v[32:33] offset:2048
    v_cvt_pk_bf16_f32 v32, v176, v177
    v_cvt_pk_bf16_f32 v33, v178, v179
    ds_write_b64 v4, v[32:33] offset:2064
    v_cvt_pk_bf16_f32 v32, v180, v181
    v_cvt_pk_bf16_f32 v33, v182, v183
    ds_write_b64 v4, v[32:33] offset:2080
    v_cvt_pk_bf16_f32 v32, v184, v185
    v_cvt_pk_bf16_f32 v33, v186, v187
    ds_write_b64 v4, v[32:33] offset:2096
    s_waitcnt lgkmcnt(0)
    ds_read_b128 v[52:55], v10 offset:0
    ds_read_b128 v[56:59], v10 offset:1024
    ds_read_b128 v[60:63], v10 offset:2048
    ds_read_b128 v[64:67], v10 offset:3072
    s_waitcnt lgkmcnt(0)
    buffer_store_dwordx4 v[52:55], v9, s[8:11], s35 offen offset:0
    buffer_store_dwordx4 v[56:59], v9, s[8:11], s35 offen offset:1024
    buffer_store_dwordx4 v[60:63], v9, s[8:11], s35 offen offset:2048
    buffer_store_dwordx4 v[64:67], v9, s[8:11], s35 offen offset:3072
    s_lshl_b32 s36, s38, 2
    s_add_u32 s35, s18, s36
    s_add_u32 s35, s35, 3
    s_lshl_b32 s35, s35, 17
    s_add_u32 s35, s35, s19
    v_cvt_pk_bf16_f32 v32, v188, v189
    v_cvt_pk_bf16_f32 v33, v190, v191
    ds_write_b64 v4, v[32:33] offset:4096
    v_cvt_pk_bf16_f32 v32, v192, v193
    v_cvt_pk_bf16_f32 v33, v194, v195
    ds_write_b64 v4, v[32:33] offset:4112
    v_cvt_pk_bf16_f32 v32, v196, v197
    v_cvt_pk_bf16_f32 v33, v198, v199
    ds_write_b64 v4, v[32:33] offset:4128
    v_cvt_pk_bf16_f32 v32, v200, v201
    v_cvt_pk_bf16_f32 v33, v202, v203
    ds_write_b64 v4, v[32:33] offset:4144
    v_cvt_pk_bf16_f32 v32, v204, v205
    v_cvt_pk_bf16_f32 v33, v206, v207
    ds_write_b64 v4, v[32:33] offset:6144
    v_cvt_pk_bf16_f32 v32, v208, v209
    v_cvt_pk_bf16_f32 v33, v210, v211
    ds_write_b64 v4, v[32:33] offset:6160
    v_cvt_pk_bf16_f32 v32, v212, v213
    v_cvt_pk_bf16_f32 v33, v214, v215
    ds_write_b64 v4, v[32:33] offset:6176
    v_cvt_pk_bf16_f32 v32, v216, v217
    v_cvt_pk_bf16_f32 v33, v218, v219
    ds_write_b64 v4, v[32:33] offset:6192
    s_waitcnt lgkmcnt(0)
    ds_read_b128 v[36:39], v10 offset:4096
    ds_read_b128 v[40:43], v10 offset:5120
    ds_read_b128 v[44:47], v10 offset:6144
    ds_read_b128 v[48:51], v10 offset:7168
    s_waitcnt lgkmcnt(0)
    buffer_store_dwordx4 v[36:39], v9, s[8:11], s35 offen offset:0
    buffer_store_dwordx4 v[40:43], v9, s[8:11], s35 offen offset:1024
    buffer_store_dwordx4 v[44:47], v9, s[8:11], s35 offen offset:2048
    buffer_store_dwordx4 v[48:51], v9, s[8:11], s35 offen offset:3072
    s_add_u32 s35, s18, s38
    s_add_u32 s35, s35, 8
    s_lshl_b32 s35, s35, 17
    s_add_u32 s35, s35, s19
    v_cvt_pk_bf16_f32 v32, v220, v221
    v_cvt_pk_bf16_f32 v33, v222, v223
    ds_write_b64 v4, v[32:33] offset:0
    v_cvt_pk_bf16_f32 v32, v224, v225
    v_cvt_pk_bf16_f32 v33, v226, v227
    ds_write_b64 v4, v[32:33] offset:16
    v_cvt_pk_bf16_f32 v32, v228, v229
    v_cvt_pk_bf16_f32 v33, v230, v231
    ds_write_b64 v4, v[32:33] offset:32
    v_cvt_pk_bf16_f32 v32, v232, v233
    v_cvt_pk_bf16_f32 v33, v234, v235
    ds_write_b64 v4, v[32:33] offset:48
    v_cvt_pk_bf16_f32 v32, v236, v237
    v_cvt_pk_bf16_f32 v33, v238, v239
    ds_write_b64 v4, v[32:33] offset:2048
    v_cvt_pk_bf16_f32 v32, v240, v241
    v_cvt_pk_bf16_f32 v33, v242, v243
    ds_write_b64 v4, v[32:33] offset:2064
    v_cvt_pk_bf16_f32 v32, v244, v245
    v_cvt_pk_bf16_f32 v33, v246, v247
    ds_write_b64 v4, v[32:33] offset:2080
    v_cvt_pk_bf16_f32 v32, v248, v249
    v_cvt_pk_bf16_f32 v33, v250, v251
    ds_write_b64 v4, v[32:33] offset:2096
    s_waitcnt lgkmcnt(0)
    ds_read_b128 v[52:55], v10 offset:0
    ds_read_b128 v[56:59], v10 offset:1024
    ds_read_b128 v[60:63], v10 offset:2048
    ds_read_b128 v[64:67], v10 offset:3072
    s_waitcnt lgkmcnt(0)
    buffer_store_dwordx4 v[52:55], v9, s[8:11], s35 offen offset:0
    buffer_store_dwordx4 v[56:59], v9, s[8:11], s35 offen offset:1024
    buffer_store_dwordx4 v[60:63], v9, s[8:11], s35 offen offset:2048
    buffer_store_dwordx4 v[64:67], v9, s[8:11], s35 offen offset:3072
L_g1_done:
    s_endpgm
.globl attn_kernel
.p2align 8
.type attn_kernel,@function
attn_kernel:
    s_cmp_ge_u32 s2, 512
    s_cbranch_scc1 L_attn_done
    s_load_dwordx2 s[26:27], s[0:1], 72
    v_lshrrev_b32 v1, 6, v0
    v_and_b32 v2, 63, v0
    s_nop 0
    v_readfirstlane_b32 s20, v1
    s_and_b32 s30, s2, 31
    s_lshr_b32 s31, s2, 5
    s_waitcnt lgkmcnt(0)
    s_add_u32 s8, s26, 4194304
    s_addc_u32 s9, s27, 0
    s_mov_b32 s10, 12582912
    s_mov_b32 s11, 0x00020000
    v_and_b32 v3, 31, v2
    v_lshrrev_b32 v4, 5, v2
    v_xor_b32 v5, 32, v2
    v_lshlrev_b32 v5, 2, v5
    s_lshl_b32 s32, s31, 7
    s_lshl_b32 s33, s20, 5
    s_add_u32 s32, s32, s33
    s_lshl_b32 s34, s30, 17
    s_lshl_b32 s35, s31, 13
    s_add_u32 s35, s35, s34
    s_add_u32 s35, s35, 8372224
    s_mul_i32 s38, s20, 6144
    s_add_u32 s35, s35, s38
    v_lshl_add_u32 v248, v2, 4, s35
    s_add_u32 m0, s38, 0
    s_nop 0
    buffer_load_dwordx4 v248, s[8:11], 0 offen lds
    s_add_u32 m0, s38, 1024
    v_add_u32 v248, 1024, v248
    buffer_load_dwordx4 v248, s[8:11], 0 offen lds
    s_add_u32 m0, s38, 2048
    v_add_u32 v248, 1024, v248
    buffer_load_dwordx4 v248, s[8:11], 0 offen lds
    s_add_u32 m0, s38, 3072
    v_add_u32 v248, 1024, v248
    buffer_load_dwordx4 v248, s[8:11], 0 offen lds
    s_add_u32 m0, s38, 4096
    v_add_u32 v248, 1024, v248
    buffer_load_dwordx4 v248, s[8:11], 0 offen lds
    s_add_u32 m0, s38, 5120
    v_add_u32 v248, 1024, v248
    buffer_load_dwordx4 v248, s[8:11], 0 offen lds
    v_add_u32 v6, s32, v3
    v_lshlrev_b32 v6, 6, v6
    v_lshl_add_u32 v6, v4, 4, v6
    v_add_u32 v6, s34, v6
    buffer_load_dwordx4 v[8:11], v6, s[8:11], 0 offen
    buffer_load_dwordx4 v[12:15], v6, s[8:11], 0 offen offset:32
    v_add_u32 v7, 4177920, v6
    buffer_load_dwordx4 v[16:19], v7, s[8:11], 0 offen
    buffer_load_dwordx4 v[20:23], v7, s[8:11], 0 offen offset:32
    v_add_u32 v7, 2048, v7
    buffer_load_dwordx4 v[24:27], v7, s[8:11], 0 offen
    buffer_load_dwordx4 v[28:31], v7, s[8:11], 0 offen offset:32
    v_add_u32 v7, 2048, v7
    buffer_load_dwordx4 v[32:35], v7, s[8:11], 0 offen
    buffer_load_dwordx4 v[36:39], v7, s[8:11], 0 offen offset:32
    v_add_u32 v7, 2048, v7
    buffer_load_dwordx4 v[40:43], v7, s[8:11], 0 offen
    buffer_load_dwordx4 v[44:47], v7, s[8:11], 0 offen offset:32
    v_add_u32 v7, 2048, v7
    buffer_load_dwordx4 v[48:51], v7, s[8:11], 0 offen
    buffer_load_dwordx4 v[52:55], v7, s[8:11], 0 offen offset:32
    v_add_u32 v7, 2048, v7
    buffer_load_dwordx4 v[56:59], v7, s[8:11], 0 offen
    buffer_load_dwordx4 v[60:63], v7, s[8:11], 0 offen offset:32
    v_add_u32 v7, 2048, v7
    buffer_load_dwordx4 v[64:67], v7, s[8:11], 0 offen
    buffer_load_dwordx4 v[68:71], v7, s[8:11], 0 offen offset:32
    v_add_u32 v7, 2048, v7
    buffer_load_dwordx4 v[72:75], v7, s[8:11], 0 offen
    buffer_load_dwordx4 v[76:79], v7, s[8:11], 0 offen offset:32
    v_add_u32 v7, 2048, v7
    buffer_load_dwordx4 v[80:83], v7, s[8:11], 0 offen
    buffer_load_dwordx4 v[84:87], v7, s[8:11], 0 offen offset:32
    v_mov_b32 v88, 0
    v_mov_b32 v89, 0
    v_mov_b32 v90, 0
    v_mov_b32 v91, 0
    v_mov_b32 v92, 0
    v_mov_b32 v93, 0
    v_mov_b32 v94, 0
    v_mov_b32 v95, 0
    v_mov_b32 v96, 0
    v_mov_b32 v97, 0
    v_mov_b32 v98, 0
    v_mov_b32 v99, 0
    v_mov_b32 v100, 0
    v_mov_b32 v101, 0
    v_mov_b32 v102, 0
    v_mov_b32 v103, 0
    v_mov_b32 v104, 0
    v_mov_b32 v105, 0
    v_mov_b32 v106, 0
    v_mov_b32 v107, 0
    v_mov_b32 v108, 0
    v_mov_b32 v109, 0
    v_mov_b32 v110, 0
    v_mov_b32 v111, 0
    v_mov_b32 v112, 0
    v_mov_b32 v113, 0
    v_mov_b32 v114, 0
    v_mov_b32 v115, 0
    v_mov_b32 v116, 0
    v_mov_b32 v117, 0
    v_mov_b32 v118, 0
    v_mov_b32 v119, 0
    v_mov_b32 v120, 0
    v_mov_b32 v121, 0
    v_mov_b32 v122, 0
    v_mov_b32 v123, 0
    v_mov_b32 v124, 0
    v_mov_b32 v125, 0
    v_mov_b32 v126, 0
    v_mov_b32 v127, 0
    v_mov_b32 v128, 0
    v_mov_b32 v129, 0
    v_mov_b32 v130, 0
    v_mov_b32 v131, 0
    v_mov_b32 v132, 0
    v_mov_b32 v133, 0
    v_mov_b32 v134, 0
    v_mov_b32 v135, 0
    v_mov_b32 v136, 0
    v_mov_b32 v137, 0
    v_mov_b32 v138, 0
    v_mov_b32 v139, 0
    v_mov_b32 v140, 0
    v_mov_b32 v141, 0
    v_mov_b32 v142, 0
    v_mov_b32 v143, 0
    v_mov_b32 v144, 0
    v_mov_b32 v145, 0
    v_mov_b32 v146, 0
    v_mov_b32 v147, 0
    v_mov_b32 v148, 0
    v_mov_b32 v149, 0
    v_mov_b32 v150, 0
    v_mov_b32 v151, 0
    v_mov_b32 v152, 0
    v_mov_b32 v153, 0
    v_mov_b32 v154, 0
    v_mov_b32 v155, 0
    v_mov_b32 v156, 0
    v_mov_b32 v157, 0
    v_mov_b32 v158, 0
    v_mov_b32 v159, 0
    v_mov_b32 v160, 0
    v_mov_b32 v161, 0
    v_mov_b32 v162, 0
    v_mov_b32 v163, 0
    v_mov_b32 v164, 0
    v_mov_b32 v165, 0
    v_mov_b32 v166, 0
    v_mov_b32 v167, 0
    v_mov_b32 v168, 0
    v_mov_b32 v169, 0
    v_mov_b32 v170, 0
    v_mov_b32 v171, 0
    v_mov_b32 v172, 0
    v_mov_b32 v173, 0
    v_mov_b32 v174, 0
    v_mov_b32 v175, 0
    v_mov_b32 v176, 0
    v_mov_b32 v177, 0
    v_mov_b32 v178, 0
    v_mov_b32 v179, 0
    v_mov_b32 v180, 0
    v_mov_b32 v181, 0
    v_mov_b32 v182, 0
    v_mov_b32 v183, 0
    v_mov_b32 v184, 0
    v_mov_b32 v185, 0
    v_mov_b32 v186, 0
    v_mov_b32 v187, 0
    v_mov_b32 v188, 0
    v_mov_b32 v189, 0
    v_mov_b32 v190, 0
    v_mov_b32 v191, 0
    v_mov_b32 v192, 0
    v_mov_b32 v193, 0
    v_mov_b32 v194, 0
    v_mov_b32 v195, 0
    v_mov_b32 v196, 0
    v_mov_b32 v197, 0
    v_mov_b32 v198, 0
    v_mov_b32 v199, 0
    v_mov_b32 v200, 0
    v_mov_b32 v201, 0
    v_mov_b32 v202, 0
    v_mov_b32 v203, 0
    v_mov_b32 v204, 0
    v_mov_b32 v205, 0
    v_mov_b32 v206, 0
    v_mov_b32 v207, 0
    v_mov_b32 v208, 0
    v_mov_b32 v209, 0
    v_mov_b32 v210, 0
    v_mov_b32 v211, 0
    v_mov_b32 v212, 0
    v_mov_b32 v213, 0
    v_mov_b32 v214, 0
    v_mov_b32 v215, 0
    v_mov_b32 v216, 0
    v_mov_b32 v217, 0
    v_mov_b32 v218, 0
    v_mov_b32 v219, 0
    v_mov_b32 v220, 0
    v_mov_b32 v221, 0
    v_mov_b32 v222, 0
    v_mov_b32 v223, 0
    v_mov_b32 v224, 0
    v_mov_b32 v225, 0
    v_mov_b32 v226, 0
    v_mov_b32 v227, 0
    v_mov_b32 v228, 0
    v_mov_b32 v229, 0
    v_mov_b32 v230, 0
    v_mov_b32 v231, 0
    v_mov_b32 v232, 0
    v_mov_b32 v233, 0
    v_mov_b32 v234, 0
    v_mov_b32 v235, 0
    v_mov_b32 v236, 0
    v_mov_b32 v237, 0
    v_mov_b32 v238, 0
    v_mov_b32 v239, 0
    v_mov_b32 v240, 0
    v_mov_b32 v241, 0
    v_mov_b32 v242, 0
    v_mov_b32 v243, 0
    v_mov_b32 v244, 0
    v_mov_b32 v245, 0
    v_mov_b32 v246, 0
    v_mov_b32 v247, 0
    v_lshlrev_b32 v248, 2, v4
    v_sub_u32 v248, v3, v248
    v_cmp_gt_i32 s[40:41], 0, v248
    v_cmp_gt_i32 s[42:43], 1, v248
    v_cmp_gt_i32 s[44:45], 2, v248
    v_cmp_gt_i32 s[46:47], 3, v248
    v_cmp_gt_i32 s[48:49], 8, v248
    v_cmp_gt_i32 s[50:51], 9, v248
    v_cmp_gt_i32 s[52:53], 10, v248
    v_cmp_gt_i32 s[54:55], 11, v248
    v_cmp_gt_i32 s[56:57], 16, v248
    v_cmp_gt_i32 s[58:59], 17, v248
    v_cmp_gt_i32 s[60:61], 18, v248
    v_cmp_gt_i32 s[62:63], 19, v248
    v_cmp_gt_i32 s[64:65], 24, v248
    v_cmp_gt_i32 s[66:67], 25, v248
    v_cmp_gt_i32 s[68:69], 26, v248
    v_cmp_gt_i32 s[70:71], 27, v248
    s_waitcnt vmcnt(0)
    v_mfma_f32_32x32x16_bf16 v[88:103], v[16:19], v[8:11], v[88:103]
    v_mfma_f32_32x32x16_bf16 v[104:119], v[24:27], v[8:11], v[104:119]
    v_mfma_f32_32x32x16_bf16 v[120:135], v[32:35], v[8:11], v[120:135]
    v_mfma_f32_32x32x16_bf16 v[136:151], v[40:43], v[8:11], v[136:151]
    v_mfma_f32_32x32x16_bf16 v[152:167], v[48:51], v[8:11], v[152:167]
    v_mfma_f32_32x32x16_bf16 v[168:183], v[56:59], v[8:11], v[168:183]
    v_mfma_f32_32x32x16_bf16 v[184:199], v[64:67], v[8:11], v[184:199]
    v_mfma_f32_32x32x16_bf16 v[200:215], v[72:75], v[8:11], v[200:215]
    v_mfma_f32_32x32x16_bf16 v[216:231], v[80:83], v[8:11], v[216:231]
    v_mfma_f32_32x32x16_bf16 v[88:103], v[20:23], v[12:15], v[88:103]
    v_mfma_f32_32x32x16_bf16 v[104:119], v[28:31], v[12:15], v[104:119]
    v_mfma_f32_32x32x16_bf16 v[120:135], v[36:39], v[12:15], v[120:135]
    v_mfma_f32_32x32x16_bf16 v[136:151], v[44:47], v[12:15], v[136:151]
    v_mfma_f32_32x32x16_bf16 v[152:167], v[52:55], v[12:15], v[152:167]
    v_mfma_f32_32x32x16_bf16 v[168:183], v[60:63], v[12:15], v[168:183]
    v_mfma_f32_32x32x16_bf16 v[184:199], v[68:71], v[12:15], v[184:199]
    v_mfma_f32_32x32x16_bf16 v[200:215], v[76:79], v[12:15], v[200:215]
    v_mfma_f32_32x32x16_bf16 v[216:231], v[84:87], v[12:15], v[216:231]
    s_nop 15
    s_nop 7
    v_mov_b32 v6, 0x3e3504f3
    v_mov_b32 v7, 0x3e3504f3
    v_cvt_pk_bf16_f32 v248, v88, v89
    v_lshlrev_b32 v88, 16, v248
    v_and_b32 v89, 0xffff0000, v248
    v_pk_mul_f32 v[88:89], v[88:89], v[6:7]
    v_cvt_pk_bf16_f32 v248, v88, v89
    v_lshlrev_b32 v88, 16, v248
    v_and_b32 v89, 0xffff0000, v248
    v_cvt_pk_bf16_f32 v248, v90, v91
    v_lshlrev_b32 v90, 16, v248
    v_and_b32 v91, 0xffff0000, v248
    v_pk_mul_f32 v[90:91], v[90:91], v[6:7]
    v_cvt_pk_bf16_f32 v248, v90, v91
    v_lshlrev_b32 v90, 16, v248
    v_and_b32 v91, 0xffff0000, v248
    v_cvt_pk_bf16_f32 v248, v92, v93
    v_lshlrev_b32 v92, 16, v248
    v_and_b32 v93, 0xffff0000, v248
    v_pk_mul_f32 v[92:93], v[92:93], v[6:7]
    v_cvt_pk_bf16_f32 v248, v92, v93
    v_lshlrev_b32 v92, 16, v248
    v_and_b32 v93, 0xffff0000, v248
    v_cvt_pk_bf16_f32 v248, v94, v95
    v_lshlrev_b32 v94, 16, v248
    v_and_b32 v95, 0xffff0000, v248
    v_pk_mul_f32 v[94:95], v[94:95], v[6:7]
    v_cvt_pk_bf16_f32 v248, v94, v95
    v_lshlrev_b32 v94, 16, v248
    v_and_b32 v95, 0xffff0000, v248
    v_cvt_pk_bf16_f32 v248, v96, v97
    v_lshlrev_b32 v96, 16, v248
    v_and_b32 v97, 0xffff0000, v248
    v_pk_mul_f32 v[96:97], v[96:97], v[6:7]
    v_cvt_pk_bf16_f32 v248, v96, v97
    v_lshlrev_b32 v96, 16, v248
    v_and_b32 v97, 0xffff0000, v248
    v_cvt_pk_bf16_f32 v248, v98, v99
    v_lshlrev_b32 v98, 16, v248
    v_and_b32 v99, 0xffff0000, v248
    v_pk_mul_f32 v[98:99], v[98:99], v[6:7]
    v_cvt_pk_bf16_f32 v248, v98, v99
    v_lshlrev_b32 v98, 16, v248
    v_and_b32 v99, 0xffff0000, v248
    v_cvt_pk_bf16_f32 v248, v100, v101
    v_lshlrev_b32 v100, 16, v248
    v_and_b32 v101, 0xffff0000, v248
    v_pk_mul_f32 v[100:101], v[100:101], v[6:7]
    v_cvt_pk_bf16_f32 v248, v100, v101
    v_lshlrev_b32 v100, 16, v248
    v_and_b32 v101, 0xffff0000, v248
    v_cvt_pk_bf16_f32 v248, v102, v103
    v_lshlrev_b32 v102, 16, v248
    v_and_b32 v103, 0xffff0000, v248
    v_pk_mul_f32 v[102:103], v[102:103], v[6:7]
    v_cvt_pk_bf16_f32 v248, v102, v103
    v_lshlrev_b32 v102, 16, v248
    v_and_b32 v103, 0xffff0000, v248
    v_cvt_pk_bf16_f32 v248, v104, v105
    v_lshlrev_b32 v104, 16, v248
    v_and_b32 v105, 0xffff0000, v248
    v_pk_mul_f32 v[104:105], v[104:105], v[6:7]
    v_cvt_pk_bf16_f32 v248, v104, v105
    v_lshlrev_b32 v104, 16, v248
    v_and_b32 v105, 0xffff0000, v248
    v_cvt_pk_bf16_f32 v248, v106, v107
    v_lshlrev_b32 v106, 16, v248
    v_and_b32 v107, 0xffff0000, v248
    v_pk_mul_f32 v[106:107], v[106:107], v[6:7]
    v_cvt_pk_bf16_f32 v248, v106, v107
    v_lshlrev_b32 v106, 16, v248
    v_and_b32 v107, 0xffff0000, v248
    v_cvt_pk_bf16_f32 v248, v108, v109
    v_lshlrev_b32 v108, 16, v248
    v_and_b32 v109, 0xffff0000, v248
    v_pk_mul_f32 v[108:109], v[108:109], v[6:7]
    v_cvt_pk_bf16_f32 v248, v108, v109
    v_lshlrev_b32 v108, 16, v248
    v_and_b32 v109, 0xffff0000, v248
    v_cvt_pk_bf16_f32 v248, v110, v111
    v_lshlrev_b32 v110, 16, v248
    v_and_b32 v111, 0xffff0000, v248
    v_pk_mul_f32 v[110:111], v[110:111], v[6:7]
    v_cvt_pk_bf16_f32 v248, v110, v111
    v_lshlrev_b32 v110, 16, v248
    v_and_b32 v111, 0xffff0000, v248
    v_cvt_pk_bf16_f32 v248, v112, v113
    v_lshlrev_b32 v112, 16, v248
    v_and_b32 v113, 0xffff0000, v248
    v_pk_mul_f32 v[112:113], v[112:113], v[6:7]
    v_cvt_pk_bf16_f32 v248, v112, v113
    v_lshlrev_b32 v112, 16, v248
    v_and_b32 v113, 0xffff0000, v248
    v_cvt_pk_bf16_f32 v248, v114, v115
    v_lshlrev_b32 v114, 16, v248
    v_and_b32 v115, 0xffff0000, v248
    v_pk_mul_f32 v[114:115], v[114:115], v[6:7]
    v_cvt_pk_bf16_f32 v248, v114, v115
    v_lshlrev_b32 v114, 16, v248
    v_and_b32 v115, 0xffff0000, v248
    v_cvt_pk_bf16_f32 v248, v116, v117
    v_lshlrev_b32 v116, 16, v248
    v_and_b32 v117, 0xffff0000, v248
    v_pk_mul_f32 v[116:117], v[116:117], v[6:7]
    v_cvt_pk_bf16_f32 v248, v116, v117
    v_lshlrev_b32 v116, 16, v248
    v_and_b32 v117, 0xffff0000, v248
    v_cvt_pk_bf16_f32 v248, v118, v119
    v_lshlrev_b32 v118, 16, v248
    v_and_b32 v119, 0xffff0000, v248
    v_pk_mul_f32 v[118:119], v[118:119], v[6:7]
    v_cvt_pk_bf16_f32 v248, v118, v119
    v_lshlrev_b32 v118, 16, v248
    v_and_b32 v119, 0xffff0000, v248
    v_cvt_pk_bf16_f32 v248, v120, v121
    v_lshlrev_b32 v120, 16, v248
    v_and_b32 v121, 0xffff0000, v248
    v_pk_mul_f32 v[120:121], v[120:121], v[6:7]
    v_cvt_pk_bf16_f32 v248, v120, v121
    v_lshlrev_b32 v120, 16, v248
    v_and_b32 v121, 0xffff0000, v248
    v_cvt_pk_bf16_f32 v248, v122, v123
    v_lshlrev_b32 v122, 16, v248
    v_and_b32 v123, 0xffff0000, v248
    v_pk_mul_f32 v[122:123], v[122:123], v[6:7]
    v_cvt_pk_bf16_f32 v248, v122, v123
    v_lshlrev_b32 v122, 16, v248
    v_and_b32 v123, 0xffff0000, v248
    v_cvt_pk_bf16_f32 v248, v124, v125
    v_lshlrev_b32 v124, 16, v248
    v_and_b32 v125, 0xffff0000, v248
    v_pk_mul_f32 v[124:125], v[124:125], v[6:7]
    v_cvt_pk_bf16_f32 v248, v124, v125
    v_lshlrev_b32 v124, 16, v248
    v_and_b32 v125, 0xffff0000, v248
    v_cvt_pk_bf16_f32 v248, v126, v127
    v_lshlrev_b32 v126, 16, v248
    v_and_b32 v127, 0xffff0000, v248
    v_pk_mul_f32 v[126:127], v[126:127], v[6:7]
    v_cvt_pk_bf16_f32 v248, v126, v127
    v_lshlrev_b32 v126, 16, v248
    v_and_b32 v127, 0xffff0000, v248
    v_cvt_pk_bf16_f32 v248, v128, v129
    v_lshlrev_b32 v128, 16, v248
    v_and_b32 v129, 0xffff0000, v248
    v_pk_mul_f32 v[128:129], v[128:129], v[6:7]
    v_cvt_pk_bf16_f32 v248, v128, v129
    v_lshlrev_b32 v128, 16, v248
    v_and_b32 v129, 0xffff0000, v248
    v_cvt_pk_bf16_f32 v248, v130, v131
    v_lshlrev_b32 v130, 16, v248
    v_and_b32 v131, 0xffff0000, v248
    v_pk_mul_f32 v[130:131], v[130:131], v[6:7]
    v_cvt_pk_bf16_f32 v248, v130, v131
    v_lshlrev_b32 v130, 16, v248
    v_and_b32 v131, 0xffff0000, v248
    v_cvt_pk_bf16_f32 v248, v132, v133
    v_lshlrev_b32 v132, 16, v248
    v_and_b32 v133, 0xffff0000, v248
    v_pk_mul_f32 v[132:133], v[132:133], v[6:7]
    v_cvt_pk_bf16_f32 v248, v132, v133
    v_lshlrev_b32 v132, 16, v248
    v_and_b32 v133, 0xffff0000, v248
    v_cvt_pk_bf16_f32 v248, v134, v135
    v_lshlrev_b32 v134, 16, v248
    v_and_b32 v135, 0xffff0000, v248
    v_pk_mul_f32 v[134:135], v[134:135], v[6:7]
    v_cvt_pk_bf16_f32 v248, v134, v135
    v_lshlrev_b32 v134, 16, v248
    v_and_b32 v135, 0xffff0000, v248
    v_cvt_pk_bf16_f32 v248, v136, v137
    v_lshlrev_b32 v136, 16, v248
    v_and_b32 v137, 0xffff0000, v248
    v_pk_mul_f32 v[136:137], v[136:137], v[6:7]
    v_cvt_pk_bf16_f32 v248, v136, v137
    v_lshlrev_b32 v136, 16, v248
    v_and_b32 v137, 0xffff0000, v248
    v_cvt_pk_bf16_f32 v248, v138, v139
    v_lshlrev_b32 v138, 16, v248
    v_and_b32 v139, 0xffff0000, v248
    v_pk_mul_f32 v[138:139], v[138:139], v[6:7]
    v_cvt_pk_bf16_f32 v248, v138, v139
    v_lshlrev_b32 v138, 16, v248
    v_and_b32 v139, 0xffff0000, v248
    v_cvt_pk_bf16_f32 v248, v140, v141
    v_lshlrev_b32 v140, 16, v248
    v_and_b32 v141, 0xffff0000, v248
    v_pk_mul_f32 v[140:141], v[140:141], v[6:7]
    v_cvt_pk_bf16_f32 v248, v140, v141
    v_lshlrev_b32 v140, 16, v248
    v_and_b32 v141, 0xffff0000, v248
    v_cvt_pk_bf16_f32 v248, v142, v143
    v_lshlrev_b32 v142, 16, v248
    v_and_b32 v143, 0xffff0000, v248
    v_pk_mul_f32 v[142:143], v[142:143], v[6:7]
    v_cvt_pk_bf16_f32 v248, v142, v143
    v_lshlrev_b32 v142, 16, v248
    v_and_b32 v143, 0xffff0000, v248
    v_cvt_pk_bf16_f32 v248, v144, v145
    v_lshlrev_b32 v144, 16, v248
    v_and_b32 v145, 0xffff0000, v248
    v_pk_mul_f32 v[144:145], v[144:145], v[6:7]
    v_cvt_pk_bf16_f32 v248, v144, v145
    v_lshlrev_b32 v144, 16, v248
    v_and_b32 v145, 0xffff0000, v248
    v_cvt_pk_bf16_f32 v248, v146, v147
    v_lshlrev_b32 v146, 16, v248
    v_and_b32 v147, 0xffff0000, v248
    v_pk_mul_f32 v[146:147], v[146:147], v[6:7]
    v_cvt_pk_bf16_f32 v248, v146, v147
    v_lshlrev_b32 v146, 16, v248
    v_and_b32 v147, 0xffff0000, v248
    v_cvt_pk_bf16_f32 v248, v148, v149
    v_lshlrev_b32 v148, 16, v248
    v_and_b32 v149, 0xffff0000, v248
    v_pk_mul_f32 v[148:149], v[148:149], v[6:7]
    v_cvt_pk_bf16_f32 v248, v148, v149
    v_lshlrev_b32 v148, 16, v248
    v_and_b32 v149, 0xffff0000, v248
    v_cvt_pk_bf16_f32 v248, v150, v151
    v_lshlrev_b32 v150, 16, v248
    v_and_b32 v151, 0xffff0000, v248
    v_pk_mul_f32 v[150:151], v[150:151], v[6:7]
    v_cvt_pk_bf16_f32 v248, v150, v151
    v_lshlrev_b32 v150, 16, v248
    v_and_b32 v151, 0xffff0000, v248
    v_cvt_pk_bf16_f32 v248, v152, v153
    v_lshlrev_b32 v152, 16, v248
    v_and_b32 v153, 0xffff0000, v248
    v_pk_mul_f32 v[152:153], v[152:153], v[6:7]
    v_cvt_pk_bf16_f32 v248, v152, v153
    v_lshlrev_b32 v152, 16, v248
    v_and_b32 v153, 0xffff0000, v248
    v_cvt_pk_bf16_f32 v248, v154, v155
    v_lshlrev_b32 v154, 16, v248
    v_and_b32 v155, 0xffff0000, v248
    v_pk_mul_f32 v[154:155], v[154:155], v[6:7]
    v_cvt_pk_bf16_f32 v248, v154, v155
    v_lshlrev_b32 v154, 16, v248
    v_and_b32 v155, 0xffff0000, v248
    v_cvt_pk_bf16_f32 v248, v156, v157
    v_lshlrev_b32 v156, 16, v248
    v_and_b32 v157, 0xffff0000, v248
    v_pk_mul_f32 v[156:157], v[156:157], v[6:7]
    v_cvt_pk_bf16_f32 v248, v156, v157
    v_lshlrev_b32 v156, 16, v248
    v_and_b32 v157, 0xffff0000, v248
    v_cvt_pk_bf16_f32 v248, v158, v159
    v_lshlrev_b32 v158, 16, v248
    v_and_b32 v159, 0xffff0000, v248
    v_pk_mul_f32 v[158:159], v[158:159], v[6:7]
    v_cvt_pk_bf16_f32 v248, v158, v159
    v_lshlrev_b32 v158, 16, v248
    v_and_b32 v159, 0xffff0000, v248
    v_cvt_pk_bf16_f32 v248, v160, v161
    v_lshlrev_b32 v160, 16, v248
    v_and_b32 v161, 0xffff0000, v248
    v_pk_mul_f32 v[160:161], v[160:161], v[6:7]
    v_cvt_pk_bf16_f32 v248, v160, v161
    v_lshlrev_b32 v160, 16, v248
    v_and_b32 v161, 0xffff0000, v248
    v_cvt_pk_bf16_f32 v248, v162, v163
    v_lshlrev_b32 v162, 16, v248
    v_and_b32 v163, 0xffff0000, v248
    v_pk_mul_f32 v[162:163], v[162:163], v[6:7]
    v_cvt_pk_bf16_f32 v248, v162, v163
    v_lshlrev_b32 v162, 16, v248
    v_and_b32 v163, 0xffff0000, v248
    v_cvt_pk_bf16_f32 v248, v164, v165
    v_lshlrev_b32 v164, 16, v248
    v_and_b32 v165, 0xffff0000, v248
    v_pk_mul_f32 v[164:165], v[164:165], v[6:7]
    v_cvt_pk_bf16_f32 v248, v164, v165
    v_lshlrev_b32 v164, 16, v248
    v_and_b32 v165, 0xffff0000, v248
    v_cvt_pk_bf16_f32 v248, v166, v167
    v_lshlrev_b32 v166, 16, v248
    v_and_b32 v167, 0xffff0000, v248
    v_pk_mul_f32 v[166:167], v[166:167], v[6:7]
    v_cvt_pk_bf16_f32 v248, v166, v167
    v_lshlrev_b32 v166, 16, v248
    v_and_b32 v167, 0xffff0000, v248
    v_cvt_pk_bf16_f32 v248, v168, v169
    v_lshlrev_b32 v168, 16, v248
    v_and_b32 v169, 0xffff0000, v248
    v_pk_mul_f32 v[168:169], v[168:169], v[6:7]
    v_cvt_pk_bf16_f32 v248, v168, v169
    v_lshlrev_b32 v168, 16, v248
    v_and_b32 v169, 0xffff0000, v248
    v_cvt_pk_bf16_f32 v248, v170, v171
    v_lshlrev_b32 v170, 16, v248
    v_and_b32 v171, 0xffff0000, v248
    v_pk_mul_f32 v[170:171], v[170:171], v[6:7]
    v_cvt_pk_bf16_f32 v248, v170, v171
    v_lshlrev_b32 v170, 16, v248
    v_and_b32 v171, 0xffff0000, v248
    v_cvt_pk_bf16_f32 v248, v172, v173
    v_lshlrev_b32 v172, 16, v248
    v_and_b32 v173, 0xffff0000, v248
    v_pk_mul_f32 v[172:173], v[172:173], v[6:7]
    v_cvt_pk_bf16_f32 v248, v172, v173
    v_lshlrev_b32 v172, 16, v248
    v_and_b32 v173, 0xffff0000, v248
    v_cvt_pk_bf16_f32 v248, v174, v175
    v_lshlrev_b32 v174, 16, v248
    v_and_b32 v175, 0xffff0000, v248
    v_pk_mul_f32 v[174:175], v[174:175], v[6:7]
    v_cvt_pk_bf16_f32 v248, v174, v175
    v_lshlrev_b32 v174, 16, v248
    v_and_b32 v175, 0xffff0000, v248
    v_cvt_pk_bf16_f32 v248, v176, v177
    v_lshlrev_b32 v176, 16, v248
    v_and_b32 v177, 0xffff0000, v248
    v_pk_mul_f32 v[176:177], v[176:177], v[6:7]
    v_cvt_pk_bf16_f32 v248, v176, v177
    v_lshlrev_b32 v176, 16, v248
    v_and_b32 v177, 0xffff0000, v248
    v_cvt_pk_bf16_f32 v248, v178, v179
    v_lshlrev_b32 v178, 16, v248
    v_and_b32 v179, 0xffff0000, v248
    v_pk_mul_f32 v[178:179], v[178:179], v[6:7]
    v_cvt_pk_bf16_f32 v248, v178, v179
    v_lshlrev_b32 v178, 16, v248
    v_and_b32 v179, 0xffff0000, v248
    v_cvt_pk_bf16_f32 v248, v180, v181
    v_lshlrev_b32 v180, 16, v248
    v_and_b32 v181, 0xffff0000, v248
    v_pk_mul_f32 v[180:181], v[180:181], v[6:7]
    v_cvt_pk_bf16_f32 v248, v180, v181
    v_lshlrev_b32 v180, 16, v248
    v_and_b32 v181, 0xffff0000, v248
    v_cvt_pk_bf16_f32 v248, v182, v183
    v_lshlrev_b32 v182, 16, v248
    v_and_b32 v183, 0xffff0000, v248
    v_pk_mul_f32 v[182:183], v[182:183], v[6:7]
    v_cvt_pk_bf16_f32 v248, v182, v183
    v_lshlrev_b32 v182, 16, v248
    v_and_b32 v183, 0xffff0000, v248
    v_cvt_pk_bf16_f32 v248, v184, v185
    v_lshlrev_b32 v184, 16, v248
    v_and_b32 v185, 0xffff0000, v248
    v_pk_mul_f32 v[184:185], v[184:185], v[6:7]
    v_cvt_pk_bf16_f32 v248, v184, v185
    v_lshlrev_b32 v184, 16, v248
    v_and_b32 v185, 0xffff0000, v248
    v_cvt_pk_bf16_f32 v248, v186, v187
    v_lshlrev_b32 v186, 16, v248
    v_and_b32 v187, 0xffff0000, v248
    v_pk_mul_f32 v[186:187], v[186:187], v[6:7]
    v_cvt_pk_bf16_f32 v248, v186, v187
    v_lshlrev_b32 v186, 16, v248
    v_and_b32 v187, 0xffff0000, v248
    v_cvt_pk_bf16_f32 v248, v188, v189
    v_lshlrev_b32 v188, 16, v248
    v_and_b32 v189, 0xffff0000, v248
    v_pk_mul_f32 v[188:189], v[188:189], v[6:7]
    v_cvt_pk_bf16_f32 v248, v188, v189
    v_lshlrev_b32 v188, 16, v248
    v_and_b32 v189, 0xffff0000, v248
    v_cvt_pk_bf16_f32 v248, v190, v191
    v_lshlrev_b32 v190, 16, v248
    v_and_b32 v191, 0xffff0000, v248
    v_pk_mul_f32 v[190:191], v[190:191], v[6:7]
    v_cvt_pk_bf16_f32 v248, v190, v191
    v_lshlrev_b32 v190, 16, v248
    v_and_b32 v191, 0xffff0000, v248
    v_cvt_pk_bf16_f32 v248, v192, v193
    v_lshlrev_b32 v192, 16, v248
    v_and_b32 v193, 0xffff0000, v248
    v_pk_mul_f32 v[192:193], v[192:193], v[6:7]
    v_cvt_pk_bf16_f32 v248, v192, v193
    v_lshlrev_b32 v192, 16, v248
    v_and_b32 v193, 0xffff0000, v248
    v_cvt_pk_bf16_f32 v248, v194, v195
    v_lshlrev_b32 v194, 16, v248
    v_and_b32 v195, 0xffff0000, v248
    v_pk_mul_f32 v[194:195], v[194:195], v[6:7]
    v_cvt_pk_bf16_f32 v248, v194, v195
    v_lshlrev_b32 v194, 16, v248
    v_and_b32 v195, 0xffff0000, v248
    v_cvt_pk_bf16_f32 v248, v196, v197
    v_lshlrev_b32 v196, 16, v248
    v_and_b32 v197, 0xffff0000, v248
    v_pk_mul_f32 v[196:197], v[196:197], v[6:7]
    v_cvt_pk_bf16_f32 v248, v196, v197
    v_lshlrev_b32 v196, 16, v248
    v_and_b32 v197, 0xffff0000, v248
    v_cvt_pk_bf16_f32 v248, v198, v199
    v_lshlrev_b32 v198, 16, v248
    v_and_b32 v199, 0xffff0000, v248
    v_pk_mul_f32 v[198:199], v[198:199], v[6:7]
    v_cvt_pk_bf16_f32 v248, v198, v199
    v_lshlrev_b32 v198, 16, v248
    v_and_b32 v199, 0xffff0000, v248
    v_cvt_pk_bf16_f32 v248, v200, v201
    v_lshlrev_b32 v200, 16, v248
    v_and_b32 v201, 0xffff0000, v248
    v_pk_mul_f32 v[200:201], v[200:201], v[6:7]
    v_cvt_pk_bf16_f32 v248, v200, v201
    v_lshlrev_b32 v200, 16, v248
    v_and_b32 v201, 0xffff0000, v248
    v_cvt_pk_bf16_f32 v248, v202, v203
    v_lshlrev_b32 v202, 16, v248
    v_and_b32 v203, 0xffff0000, v248
    v_pk_mul_f32 v[202:203], v[202:203], v[6:7]
    v_cvt_pk_bf16_f32 v248, v202, v203
    v_lshlrev_b32 v202, 16, v248
    v_and_b32 v203, 0xffff0000, v248
    v_cvt_pk_bf16_f32 v248, v204, v205
    v_lshlrev_b32 v204, 16, v248
    v_and_b32 v205, 0xffff0000, v248
    v_pk_mul_f32 v[204:205], v[204:205], v[6:7]
    v_cvt_pk_bf16_f32 v248, v204, v205
    v_lshlrev_b32 v204, 16, v248
    v_and_b32 v205, 0xffff0000, v248
    v_cvt_pk_bf16_f32 v248, v206, v207
    v_lshlrev_b32 v206, 16, v248
    v_and_b32 v207, 0xffff0000, v248
    v_pk_mul_f32 v[206:207], v[206:207], v[6:7]
    v_cvt_pk_bf16_f32 v248, v206, v207
    v_lshlrev_b32 v206, 16, v248
    v_and_b32 v207, 0xffff0000, v248
    v_cvt_pk_bf16_f32 v248, v208, v209
    v_lshlrev_b32 v208, 16, v248
    v_and_b32 v209, 0xffff0000, v248
    v_pk_mul_f32 v[208:209], v[208:209], v[6:7]
    v_cvt_pk_bf16_f32 v248, v208, v209
    v_lshlrev_b32 v208, 16, v248
    v_and_b32 v209, 0xffff0000, v248
    v_cvt_pk_bf16_f32 v248, v210, v211
    v_lshlrev_b32 v210, 16, v248
    v_and_b32 v211, 0xffff0000, v248
    v_pk_mul_f32 v[210:211], v[210:211], v[6:7]
    v_cvt_pk_bf16_f32 v248, v210, v211
    v_lshlrev_b32 v210, 16, v248
    v_and_b32 v211, 0xffff0000, v248
    v_cvt_pk_bf16_f32 v248, v212, v213
    v_lshlrev_b32 v212, 16, v248
    v_and_b32 v213, 0xffff0000, v248
    v_pk_mul_f32 v[212:213], v[212:213], v[6:7]
    v_cvt_pk_bf16_f32 v248, v212, v213
    v_lshlrev_b32 v212, 16, v248
    v_and_b32 v213, 0xffff0000, v248
    v_cvt_pk_bf16_f32 v248, v214, v215
    v_lshlrev_b32 v214, 16, v248
    v_and_b32 v215, 0xffff0000, v248
    v_pk_mul_f32 v[214:215], v[214:215], v[6:7]
    v_cvt_pk_bf16_f32 v248, v214, v215
    v_lshlrev_b32 v214, 16, v248
    v_and_b32 v215, 0xffff0000, v248
    v_cvt_pk_bf16_f32 v248, v216, v217
    v_lshlrev_b32 v216, 16, v248
    v_and_b32 v217, 0xffff0000, v248
    v_pk_mul_f32 v[216:217], v[216:217], v[6:7]
    v_cvt_pk_bf16_f32 v248, v216, v217
    v_lshlrev_b32 v216, 16, v248
    v_and_b32 v217, 0xffff0000, v248
    v_cvt_pk_bf16_f32 v248, v218, v219
    v_lshlrev_b32 v218, 16, v248
    v_and_b32 v219, 0xffff0000, v248
    v_pk_mul_f32 v[218:219], v[218:219], v[6:7]
    v_cvt_pk_bf16_f32 v248, v218, v219
    v_lshlrev_b32 v218, 16, v248
    v_and_b32 v219, 0xffff0000, v248
    v_cvt_pk_bf16_f32 v248, v220, v221
    v_lshlrev_b32 v220, 16, v248
    v_and_b32 v221, 0xffff0000, v248
    v_pk_mul_f32 v[220:221], v[220:221], v[6:7]
    v_cvt_pk_bf16_f32 v248, v220, v221
    v_lshlrev_b32 v220, 16, v248
    v_and_b32 v221, 0xffff0000, v248
    v_cvt_pk_bf16_f32 v248, v222, v223
    v_lshlrev_b32 v222, 16, v248
    v_and_b32 v223, 0xffff0000, v248
    v_pk_mul_f32 v[222:223], v[222:223], v[6:7]
    v_cvt_pk_bf16_f32 v248, v222, v223
    v_lshlrev_b32 v222, 16, v248
    v_and_b32 v223, 0xffff0000, v248
    v_cvt_pk_bf16_f32 v248, v224, v225
    v_lshlrev_b32 v224, 16, v248
    v_and_b32 v225, 0xffff0000, v248
    v_pk_mul_f32 v[224:225], v[224:225], v[6:7]
    v_cvt_pk_bf16_f32 v248, v224, v225
    v_lshlrev_b32 v224, 16, v248
    v_and_b32 v225, 0xffff0000, v248
    v_cvt_pk_bf16_f32 v248, v226, v227
    v_lshlrev_b32 v226, 16, v248
    v_and_b32 v227, 0xffff0000, v248
    v_pk_mul_f32 v[226:227], v[226:227], v[6:7]
    v_cvt_pk_bf16_f32 v248, v226, v227
    v_lshlrev_b32 v226, 16, v248
    v_and_b32 v227, 0xffff0000, v248
    v_cvt_pk_bf16_f32 v248, v228, v229
    v_lshlrev_b32 v228, 16, v248
    v_and_b32 v229, 0xffff0000, v248
    v_pk_mul_f32 v[228:229], v[228:229], v[6:7]
    v_cvt_pk_bf16_f32 v248, v228, v229
    v_lshlrev_b32 v228, 16, v248
    v_and_b32 v229, 0xffff0000, v248
    v_cvt_pk_bf16_f32 v248, v230, v231
    v_lshlrev_b32 v230, 16, v248
    v_and_b32 v231, 0xffff0000, v248
    v_pk_mul_f32 v[230:231], v[230:231], v[6:7]
    v_cvt_pk_bf16_f32 v248, v230, v231
    v_lshlrev_b32 v230, 16, v248
    v_and_b32 v231, 0xffff0000, v248
    s_mov_b32 s37, 0xce6e6b28
    v_mov_b32 v248, s37
    v_cndmask_b32 v88, v248, v88, s[40:41]
    v_cndmask_b32 v216, v216, v248, s[40:41]
    v_cndmask_b32 v89, v248, v89, s[42:43]
    v_cndmask_b32 v217, v217, v248, s[42:43]
    v_cndmask_b32 v90, v248, v90, s[44:45]
    v_cndmask_b32 v218, v218, v248, s[44:45]
    v_cndmask_b32 v91, v248, v91, s[46:47]
    v_cndmask_b32 v219, v219, v248, s[46:47]
    v_cndmask_b32 v92, v248, v92, s[48:49]
    v_cndmask_b32 v220, v220, v248, s[48:49]
    v_cndmask_b32 v93, v248, v93, s[50:51]
    v_cndmask_b32 v221, v221, v248, s[50:51]
    v_cndmask_b32 v94, v248, v94, s[52:53]
    v_cndmask_b32 v222, v222, v248, s[52:53]
    v_cndmask_b32 v95, v248, v95, s[54:55]
    v_cndmask_b32 v223, v223, v248, s[54:55]
    v_cndmask_b32 v96, v248, v96, s[56:57]
    v_cndmask_b32 v224, v224, v248, s[56:57]
    v_cndmask_b32 v97, v248, v97, s[58:59]
    v_cndmask_b32 v225, v225, v248, s[58:59]
    v_cndmask_b32 v98, v248, v98, s[60:61]
    v_cndmask_b32 v226, v226, v248, s[60:61]
    v_cndmask_b32 v99, v248, v99, s[62:63]
    v_cndmask_b32 v227, v227, v248, s[62:63]
    v_cndmask_b32 v100, v248, v100, s[64:65]
    v_cndmask_b32 v228, v228, v248, s[64:65]
    v_cndmask_b32 v101, v248, v101, s[66:67]
    v_cndmask_b32 v229, v229, v248, s[66:67]
    v_cndmask_b32 v102, v248, v102, s[68:69]
    v_cndmask_b32 v230, v230, v248, s[68:69]
    v_cndmask_b32 v103, v248, v103, s[70:71]
    v_cndmask_b32 v231, v231, v248, s[70:71]
    s_lshr_b32 s35, s32, 5
    s_sub_i32 s35, 8, s35
    s_cmp_gt_i32 s35, 0
    s_cbranch_scc0 L_attn_nbdone
    v_mov_b32 v88, v248
    v_mov_b32 v89, v248
    v_mov_b32 v90, v248
    v_mov_b32 v91, v248
    v_mov_b32 v92, v248
    v_mov_b32 v93, v248
    v_mov_b32 v94, v248
    v_mov_b32 v95, v248
    v_mov_b32 v96, v248
    v_mov_b32 v97, v248
    v_mov_b32 v98, v248
    v_mov_b32 v99, v248
    v_mov_b32 v100, v248
    v_mov_b32 v101, v248
    v_mov_b32 v102, v248
    v_mov_b32 v103, v248
    s_cmp_gt_i32 s35, 1
    s_cbranch_scc0 L_attn_nbdone
    v_mov_b32 v104, v248
    v_mov_b32 v105, v248
    v_mov_b32 v106, v248
    v_mov_b32 v107, v248
    v_mov_b32 v108, v248
    v_mov_b32 v109, v248
    v_mov_b32 v110, v248
    v_mov_b32 v111, v248
    v_mov_b32 v112, v248
    v_mov_b32 v113, v248
    v_mov_b32 v114, v248
    v_mov_b32 v115, v248
    v_mov_b32 v116, v248
    v_mov_b32 v117, v248
    v_mov_b32 v118, v248
    v_mov_b32 v119, v248
    s_cmp_gt_i32 s35, 2
    s_cbranch_scc0 L_attn_nbdone
    v_mov_b32 v120, v248
    v_mov_b32 v121, v248
    v_mov_b32 v122, v248
    v_mov_b32 v123, v248
    v_mov_b32 v124, v248
    v_mov_b32 v125, v248
    v_mov_b32 v126, v248
    v_mov_b32 v127, v248
    v_mov_b32 v128, v248
    v_mov_b32 v129, v248
    v_mov_b32 v130, v248
    v_mov_b32 v131, v248
    v_mov_b32 v132, v248
    v_mov_b32 v133, v248
    v_mov_b32 v134, v248
    v_mov_b32 v135, v248
    s_cmp_gt_i32 s35, 3
    s_cbranch_scc0 L_attn_nbdone
    v_mov_b32 v136, v248
    v_mov_b32 v137, v248
    v_mov_b32 v138, v248
    v_mov_b32 v139, v248
    v_mov_b32 v140, v248
    v_mov_b32 v141, v248
    v_mov_b32 v142, v248
    v_mov_b32 v143, v248
    v_mov_b32 v144, v248
    v_mov_b32 v145, v248
    v_mov_b32 v146, v248
    v_mov_b32 v147, v248
    v_mov_b32 v148, v248
    v_mov_b32 v149, v248
    v_mov_b32 v150, v248
    v_mov_b32 v151, v248
    s_cmp_gt_i32 s35, 4
    s_cbranch_scc0 L_attn_nbdone
    v_mov_b32 v152, v248
    v_mov_b32 v153, v248
    v_mov_b32 v154, v248
    v_mov_b32 v155, v248
    v_mov_b32 v156, v248
    v_mov_b32 v157, v248
    v_mov_b32 v158, v248
    v_mov_b32 v159, v248
    v_mov_b32 v160, v248
    v_mov_b32 v161, v248
    v_mov_b32 v162, v248
    v_mov_b32 v163, v248
    v_mov_b32 v164, v248
    v_mov_b32 v165, v248
    v_mov_b32 v166, v248
    v_mov_b32 v167, v248
    s_cmp_gt_i32 s35, 5
    s_cbranch_scc0 L_attn_nbdone
    v_mov_b32 v168, v248
    v_mov_b32 v169, v248
    v_mov_b32 v170, v248
    v_mov_b32 v171, v248
    v_mov_b32 v172, v248
    v_mov_b32 v173, v248
    v_mov_b32 v174, v248
    v_mov_b32 v175, v248
    v_mov_b32 v176, v248
    v_mov_b32 v177, v248
    v_mov_b32 v178, v248
    v_mov_b32 v179, v248
    v_mov_b32 v180, v248
    v_mov_b32 v181, v248
    v_mov_b32 v182, v248
    v_mov_b32 v183, v248
    s_cmp_gt_i32 s35, 6
    s_cbranch_scc0 L_attn_nbdone
    v_mov_b32 v184, v248
    v_mov_b32 v185, v248
    v_mov_b32 v186, v248
    v_mov_b32 v187, v248
    v_mov_b32 v188, v248
    v_mov_b32 v189, v248
    v_mov_b32 v190, v248
    v_mov_b32 v191, v248
    v_mov_b32 v192, v248
    v_mov_b32 v193, v248
    v_mov_b32 v194, v248
    v_mov_b32 v195, v248
    v_mov_b32 v196, v248
    v_mov_b32 v197, v248
    v_mov_b32 v198, v248
    v_mov_b32 v199, v248
    s_cmp_gt_i32 s35, 7
    s_cbranch_scc0 L_attn_nbdone
    v_mov_b32 v200, v248
    v_mov_b32 v201, v248
    v_mov_b32 v202, v248
    v_mov_b32 v203, v248
    v_mov_b32 v204, v248
    v_mov_b32 v205, v248
    v_mov_b32 v206, v248
    v_mov_b32 v207, v248
    v_mov_b32 v208, v248
    v_mov_b32 v209, v248
    v_mov_b32 v210, v248
    v_mov_b32 v211, v248
    v_mov_b32 v212, v248
    v_mov_b32 v213, v248
    v_mov_b32 v214, v248
    v_mov_b32 v215, v248
L_attn_nbdone:
    v_max_f32 v249, v88, v89
    v_max3_f32 v249, v249, v90, v91
    v_max3_f32 v249, v249, v92, v93
    v_max3_f32 v249, v249, v94, v95
    v_max3_f32 v249, v249, v96, v97
    v_max3_f32 v249, v249, v98, v99
    v_max3_f32 v249, v249, v100, v101
    v_max3_f32 v249, v249, v102, v103
    v_max3_f32 v249, v249, v104, v105
    v_max3_f32 v249, v249, v106, v107
    v_max3_f32 v249, v249, v108, v109
    v_max3_f32 v249, v249, v110, v111
    v_max3_f32 v249, v249, v112, v113
    v_max3_f32 v249, v249, v114, v115
    v_max3_f32 v249, v249, v116, v117
    v_max3_f32 v249, v249, v118, v119
    v_max3_f32 v249, v249, v120, v121
    v_max3_f32 v249, v249, v122, v123
    v_max3_f32 v249, v249, v124, v125
    v_max3_f32 v249, v249, v126, v127
    v_max3_f32 v249, v249, v128, v129
    v_max3_f32 v249, v249, v130, v131
    v_max3_f32 v249, v249, v132, v133
    v_max3_f32 v249, v249, v134, v135
    v_max3_f32 v249, v249, v136, v137
    v_max3_f32 v249, v249, v138, v139
    v_max3_f32 v249, v249, v140, v141
    v_max3_f32 v249, v249, v142, v143
    v_max3_f32 v249, v249, v144, v145
    v_max3_f32 v249, v249, v146, v147
    v_max3_f32 v249, v249, v148, v149
    v_max3_f32 v249, v249, v150, v151
    v_max3_f32 v249, v249, v152, v153
    v_max3_f32 v249, v249, v154, v155
    v_max3_f32 v249, v249, v156, v157
    v_max3_f32 v249, v249, v158, v159
    v_max3_f32 v249, v249, v160, v161
    v_max3_f32 v249, v249, v162, v163
    v_max3_f32 v249, v249, v164, v165
    v_max3_f32 v249, v249, v166, v167
    v_max3_f32 v249, v249, v168, v169
    v_max3_f32 v249, v249, v170, v171
    v_max3_f32 v249, v249, v172, v173
    v_max3_f32 v249, v249, v174, v175
    v_max3_f32 v249, v249, v176, v177
    v_max3_f32 v249, v249, v178, v179
    v_max3_f32 v249, v249, v180, v181
    v_max3_f32 v249, v249, v182, v183
    v_max3_f32 v249, v249, v184, v185
    v_max3_f32 v249, v249, v186, v187
    v_max3_f32 v249, v249, v188, v189
    v_max3_f32 v249, v249, v190, v191
    v_max3_f32 v249, v249, v192, v193
    v_max3_f32 v249, v249, v194, v195
    v_max3_f32 v249, v249, v196, v197
    v_max3_f32 v249, v249, v198, v199
    v_max3_f32 v249, v249, v200, v201
    v_max3_f32 v249, v249, v202, v203
    v_max3_f32 v249, v249, v204, v205
    v_max3_f32 v249, v249, v206, v207
    v_max3_f32 v249, v249, v208, v209
    v_max3_f32 v249, v249, v210, v211
    v_max3_f32 v249, v249, v212, v213
    v_max3_f32 v249, v249, v214, v215
    v_max3_f32 v249, v249, v216, v217
    v_max3_f32 v249, v249, v218, v219
    v_max3_f32 v249, v249, v220, v221
    v_max3_f32 v249, v249, v222, v223
    v_max3_f32 v249, v249, v224, v225
    v_max3_f32 v249, v249, v226, v227
    v_max3_f32 v249, v249, v228, v229
    v_max3_f32 v249, v249, v230, v231
    ds_bpermute_b32 v250, v5, v249
    s_waitcnt lgkmcnt(0)
    v_max_f32 v249, v249, v250
    s_mov_b32 s37, 0x3fb8aa3b
    v_mul_f32 v250, s37, v249
    v_sub_f32 v250, 0, v250
    v_mov_b32 v251, v250
    v_mov_b32 v6, s37
    v_mov_b32 v7, s37
    v_pk_fma_f32 v[88:89], v[88:89], v[6:7], v[250:251]
    v_pk_fma_f32 v[90:91], v[90:91], v[6:7], v[250:251]
    v_pk_fma_f32 v[92:93], v[92:93], v[6:7], v[250:251]
    v_pk_fma_f32 v[94:95], v[94:95], v[6:7], v[250:251]
    v_pk_fma_f32 v[96:97], v[96:97], v[6:7], v[250:251]
    v_pk_fma_f32 v[98:99], v[98:99], v[6:7], v[250:251]
    v_pk_fma_f32 v[100:101], v[100:101], v[6:7], v[250:251]
    v_pk_fma_f32 v[102:103], v[102:103], v[6:7], v[250:251]
    v_pk_fma_f32 v[104:105], v[104:105], v[6:7], v[250:251]
    v_pk_fma_f32 v[106:107], v[106:107], v[6:7], v[250:251]
    v_pk_fma_f32 v[108:109], v[108:109], v[6:7], v[250:251]
    v_pk_fma_f32 v[110:111], v[110:111], v[6:7], v[250:251]
    v_pk_fma_f32 v[112:113], v[112:113], v[6:7], v[250:251]
    v_pk_fma_f32 v[114:115], v[114:115], v[6:7], v[250:251]
    v_pk_fma_f32 v[116:117], v[116:117], v[6:7], v[250:251]
    v_pk_fma_f32 v[118:119], v[118:119], v[6:7], v[250:251]
    v_pk_fma_f32 v[120:121], v[120:121], v[6:7], v[250:251]
    v_pk_fma_f32 v[122:123], v[122:123], v[6:7], v[250:251]
    v_pk_fma_f32 v[124:125], v[124:125], v[6:7], v[250:251]
    v_pk_fma_f32 v[126:127], v[126:127], v[6:7], v[250:251]
    v_pk_fma_f32 v[128:129], v[128:129], v[6:7], v[250:251]
    v_pk_fma_f32 v[130:131], v[130:131], v[6:7], v[250:251]
    v_pk_fma_f32 v[132:133], v[132:133], v[6:7], v[250:251]
    v_pk_fma_f32 v[134:135], v[134:135], v[6:7], v[250:251]
    v_pk_fma_f32 v[136:137], v[136:137], v[6:7], v[250:251]
    v_pk_fma_f32 v[138:139], v[138:139], v[6:7], v[250:251]
    v_pk_fma_f32 v[140:141], v[140:141], v[6:7], v[250:251]
    v_pk_fma_f32 v[142:143], v[142:143], v[6:7], v[250:251]
    v_pk_fma_f32 v[144:145], v[144:145], v[6:7], v[250:251]
    v_pk_fma_f32 v[146:147], v[146:147], v[6:7], v[250:251]
    v_pk_fma_f32 v[148:149], v[148:149], v[6:7], v[250:251]
    v_pk_fma_f32 v[150:151], v[150:151], v[6:7], v[250:251]
    v_pk_fma_f32 v[152:153], v[152:153], v[6:7], v[250:251]
    v_pk_fma_f32 v[154:155], v[154:155], v[6:7], v[250:251]
    v_pk_fma_f32 v[156:157], v[156:157], v[6:7], v[250:251]
    v_pk_fma_f32 v[158:159], v[158:159], v[6:7], v[250:251]
    v_pk_fma_f32 v[160:161], v[160:161], v[6:7], v[250:251]
    v_pk_fma_f32 v[162:163], v[162:163], v[6:7], v[250:251]
    v_pk_fma_f32 v[164:165], v[164:165], v[6:7], v[250:251]
    v_pk_fma_f32 v[166:167], v[166:167], v[6:7], v[250:251]
    v_pk_fma_f32 v[168:169], v[168:169], v[6:7], v[250:251]
    v_pk_fma_f32 v[170:171], v[170:171], v[6:7], v[250:251]
    v_pk_fma_f32 v[172:173], v[172:173], v[6:7], v[250:251]
    v_pk_fma_f32 v[174:175], v[174:175], v[6:7], v[250:251]
    v_pk_fma_f32 v[176:177], v[176:177], v[6:7], v[250:251]
    v_pk_fma_f32 v[178:179], v[178:179], v[6:7], v[250:251]
    v_pk_fma_f32 v[180:181], v[180:181], v[6:7], v[250:251]
    v_pk_fma_f32 v[182:183], v[182:183], v[6:7], v[250:251]
    v_pk_fma_f32 v[184:185], v[184:185], v[6:7], v[250:251]
    v_pk_fma_f32 v[186:187], v[186:187], v[6:7], v[250:251]
    v_pk_fma_f32 v[188:189], v[188:189], v[6:7], v[250:251]
    v_pk_fma_f32 v[190:191], v[190:191], v[6:7], v[250:251]
    v_pk_fma_f32 v[192:193], v[192:193], v[6:7], v[250:251]
    v_pk_fma_f32 v[194:195], v[194:195], v[6:7], v[250:251]
    v_pk_fma_f32 v[196:197], v[196:197], v[6:7], v[250:251]
    v_pk_fma_f32 v[198:199], v[198:199], v[6:7], v[250:251]
    v_pk_fma_f32 v[200:201], v[200:201], v[6:7], v[250:251]
    v_pk_fma_f32 v[202:203], v[202:203], v[6:7], v[250:251]
    v_pk_fma_f32 v[204:205], v[204:205], v[6:7], v[250:251]
    v_pk_fma_f32 v[206:207], v[206:207], v[6:7], v[250:251]
    v_pk_fma_f32 v[208:209], v[208:209], v[6:7], v[250:251]
    v_pk_fma_f32 v[210:211], v[210:211], v[6:7], v[250:251]
    v_pk_fma_f32 v[212:213], v[212:213], v[6:7], v[250:251]
    v_pk_fma_f32 v[214:215], v[214:215], v[6:7], v[250:251]
    v_pk_fma_f32 v[216:217], v[216:217], v[6:7], v[250:251]
    v_pk_fma_f32 v[218:219], v[218:219], v[6:7], v[250:251]
    v_pk_fma_f32 v[220:221], v[220:221], v[6:7], v[250:251]
    v_pk_fma_f32 v[222:223], v[222:223], v[6:7], v[250:251]
    v_pk_fma_f32 v[224:225], v[224:225], v[6:7], v[250:251]
    v_pk_fma_f32 v[226:227], v[226:227], v[6:7], v[250:251]
    v_pk_fma_f32 v[228:229], v[228:229], v[6:7], v[250:251]
    v_pk_fma_f32 v[230:231], v[230:231], v[6:7], v[250:251]
    v_exp_f32 v88, v88
    v_exp_f32 v89, v89
    v_exp_f32 v90, v90
    v_exp_f32 v91, v91
    v_exp_f32 v92, v92
    v_exp_f32 v93, v93
    v_exp_f32 v94, v94
    v_exp_f32 v95, v95
    v_exp_f32 v96, v96
    v_exp_f32 v97, v97
    v_exp_f32 v98, v98
    v_exp_f32 v99, v99
    v_exp_f32 v100, v100
    v_exp_f32 v101, v101
    v_exp_f32 v102, v102
    v_exp_f32 v103, v103
    v_exp_f32 v104, v104
    v_exp_f32 v105, v105
    v_exp_f32 v106, v106
    v_exp_f32 v107, v107
    v_exp_f32 v108, v108
    v_exp_f32 v109, v109
    v_exp_f32 v110, v110
    v_exp_f32 v111, v111
    v_exp_f32 v112, v112
    v_exp_f32 v113, v113
    v_exp_f32 v114, v114
    v_exp_f32 v115, v115
    v_exp_f32 v116, v116
    v_exp_f32 v117, v117
    v_exp_f32 v118, v118
    v_exp_f32 v119, v119
    v_exp_f32 v120, v120
    v_exp_f32 v121, v121
    v_exp_f32 v122, v122
    v_exp_f32 v123, v123
    v_exp_f32 v124, v124
    v_exp_f32 v125, v125
    v_exp_f32 v126, v126
    v_exp_f32 v127, v127
    v_exp_f32 v128, v128
    v_exp_f32 v129, v129
    v_exp_f32 v130, v130
    v_exp_f32 v131, v131
    v_exp_f32 v132, v132
    v_exp_f32 v133, v133
    v_exp_f32 v134, v134
    v_exp_f32 v135, v135
    v_exp_f32 v136, v136
    v_exp_f32 v137, v137
    v_exp_f32 v138, v138
    v_exp_f32 v139, v139
    v_exp_f32 v140, v140
    v_exp_f32 v141, v141
    v_exp_f32 v142, v142
    v_exp_f32 v143, v143
    v_exp_f32 v144, v144
    v_exp_f32 v145, v145
    v_exp_f32 v146, v146
    v_exp_f32 v147, v147
    v_exp_f32 v148, v148
    v_exp_f32 v149, v149
    v_exp_f32 v150, v150
    v_exp_f32 v151, v151
    v_exp_f32 v152, v152
    v_exp_f32 v153, v153
    v_exp_f32 v154, v154
    v_exp_f32 v155, v155
    v_exp_f32 v156, v156
    v_exp_f32 v157, v157
    v_exp_f32 v158, v158
    v_exp_f32 v159, v159
    v_exp_f32 v160, v160
    v_exp_f32 v161, v161
    v_exp_f32 v162, v162
    v_exp_f32 v163, v163
    v_exp_f32 v164, v164
    v_exp_f32 v165, v165
    v_exp_f32 v166, v166
    v_exp_f32 v167, v167
    v_exp_f32 v168, v168
    v_exp_f32 v169, v169
    v_exp_f32 v170, v170
    v_exp_f32 v171, v171
    v_exp_f32 v172, v172
    v_exp_f32 v173, v173
    v_exp_f32 v174, v174
    v_exp_f32 v175, v175
    v_exp_f32 v176, v176
    v_exp_f32 v177, v177
    v_exp_f32 v178, v178
    v_exp_f32 v179, v179
    v_exp_f32 v180, v180
    v_exp_f32 v181, v181
    v_exp_f32 v182, v182
    v_exp_f32 v183, v183
    v_exp_f32 v184, v184
    v_exp_f32 v185, v185
    v_exp_f32 v186, v186
    v_exp_f32 v187, v187
    v_exp_f32 v188, v188
    v_exp_f32 v189, v189
    v_exp_f32 v190, v190
    v_exp_f32 v191, v191
    v_exp_f32 v192, v192
    v_exp_f32 v193, v193
    v_exp_f32 v194, v194
    v_exp_f32 v195, v195
    v_exp_f32 v196, v196
    v_exp_f32 v197, v197
    v_exp_f32 v198, v198
    v_exp_f32 v199, v199
    v_exp_f32 v200, v200
    v_exp_f32 v201, v201
    v_exp_f32 v202, v202
    v_exp_f32 v203, v203
    v_exp_f32 v204, v204
    v_exp_f32 v205, v205
    v_exp_f32 v206, v206
    v_exp_f32 v207, v207
    v_exp_f32 v208, v208
    v_exp_f32 v209, v209
    v_exp_f32 v210, v210
    v_exp_f32 v211, v211
    v_exp_f32 v212, v212
    v_exp_f32 v213, v213
    v_exp_f32 v214, v214
    v_exp_f32 v215, v215
    v_exp_f32 v216, v216
    v_exp_f32 v217, v217
    v_exp_f32 v218, v218
    v_exp_f32 v219, v219
    v_exp_f32 v220, v220
    v_exp_f32 v221, v221
    v_exp_f32 v222, v222
    v_exp_f32 v223, v223
    v_exp_f32 v224, v224
    v_exp_f32 v225, v225
    v_exp_f32 v226, v226
    v_exp_f32 v227, v227
    v_exp_f32 v228, v228
    v_exp_f32 v229, v229
    v_exp_f32 v230, v230
    v_exp_f32 v231, v231
    s_nop 0
    v_pk_add_f32 v[250:251], v[88:89], v[90:91]
    v_pk_add_f32 v[250:251], v[250:251], v[92:93]
    v_pk_add_f32 v[250:251], v[250:251], v[94:95]
    v_pk_add_f32 v[250:251], v[250:251], v[96:97]
    v_pk_add_f32 v[250:251], v[250:251], v[98:99]
    v_pk_add_f32 v[250:251], v[250:251], v[100:101]
    v_pk_add_f32 v[250:251], v[250:251], v[102:103]
    v_pk_add_f32 v[250:251], v[250:251], v[104:105]
    v_pk_add_f32 v[250:251], v[250:251], v[106:107]
    v_pk_add_f32 v[250:251], v[250:251], v[108:109]
    v_pk_add_f32 v[250:251], v[250:251], v[110:111]
    v_pk_add_f32 v[250:251], v[250:251], v[112:113]
    v_pk_add_f32 v[250:251], v[250:251], v[114:115]
    v_pk_add_f32 v[250:251], v[250:251], v[116:117]
    v_pk_add_f32 v[250:251], v[250:251], v[118:119]
    v_pk_add_f32 v[250:251], v[250:251], v[120:121]
    v_pk_add_f32 v[250:251], v[250:251], v[122:123]
    v_pk_add_f32 v[250:251], v[250:251], v[124:125]
    v_pk_add_f32 v[250:251], v[250:251], v[126:127]
    v_pk_add_f32 v[250:251], v[250:251], v[128:129]
    v_pk_add_f32 v[250:251], v[250:251], v[130:131]
    v_pk_add_f32 v[250:251], v[250:251], v[132:133]
    v_pk_add_f32 v[250:251], v[250:251], v[134:135]
    v_pk_add_f32 v[250:251], v[250:251], v[136:137]
    v_pk_add_f32 v[250:251], v[250:251], v[138:139]
    v_pk_add_f32 v[250:251], v[250:251], v[140:141]
    v_pk_add_f32 v[250:251], v[250:251], v[142:143]
    v_pk_add_f32 v[250:251], v[250:251], v[144:145]
    v_pk_add_f32 v[250:251], v[250:251], v[146:147]
    v_pk_add_f32 v[250:251], v[250:251], v[148:149]
    v_pk_add_f32 v[250:251], v[250:251], v[150:151]
    v_pk_add_f32 v[250:251], v[250:251], v[152:153]
    v_pk_add_f32 v[250:251], v[250:251], v[154:155]
    v_pk_add_f32 v[250:251], v[250:251], v[156:157]
    v_pk_add_f32 v[250:251], v[250:251], v[158:159]
    v_pk_add_f32 v[250:251], v[250:251], v[160:161]
    v_pk_add_f32 v[250:251], v[250:251], v[162:163]
    v_pk_add_f32 v[250:251], v[250:251], v[164:165]
    v_pk_add_f32 v[250:251], v[250:251], v[166:167]
    v_pk_add_f32 v[250:251], v[250:251], v[168:169]
    v_pk_add_f32 v[250:251], v[250:251], v[170:171]
    v_pk_add_f32 v[250:251], v[250:251], v[172:173]
    v_pk_add_f32 v[250:251], v[250:251], v[174:175]
    v_pk_add_f32 v[250:251], v[250:251], v[176:177]
    v_pk_add_f32 v[250:251], v[250:251], v[178:179]
    v_pk_add_f32 v[250:251], v[250:251], v[180:181]
    v_pk_add_f32 v[250:251], v[250:251], v[182:183]
    v_pk_add_f32 v[250:251], v[250:251], v[184:185]
    v_pk_add_f32 v[250:251], v[250:251], v[186:187]
    v_pk_add_f32 v[250:251], v[250:251], v[188:189]
    v_pk_add_f32 v[250:251], v[250:251], v[190:191]
    v_pk_add_f32 v[250:251], v[250:251], v[192:193]
    v_pk_add_f32 v[250:251], v[250:251], v[194:195]
    v_pk_add_f32 v[250:251], v[250:251], v[196:197]
    v_pk_add_f32 v[250:251], v[250:251], v[198:199]
    v_pk_add_f32 v[250:251], v[250:251], v[200:201]
    v_pk_add_f32 v[250:251], v[250:251], v[202:203]
    v_pk_add_f32 v[250:251], v[250:251], v[204:205]
    v_pk_add_f32 v[250:251], v[250:251], v[206:207]
    v_pk_add_f32 v[250:251], v[250:251], v[208:209]
    v_pk_add_f32 v[250:251], v[250:251], v[210:211]
    v_pk_add_f32 v[250:251], v[250:251], v[212:213]
    v_pk_add_f32 v[250:251], v[250:251], v[214:215]
    v_pk_add_f32 v[250:251], v[250:251], v[216:217]
    v_pk_add_f32 v[250:251], v[250:251], v[218:219]
    v_pk_add_f32 v[250:251], v[250:251], v[220:221]
    v_pk_add_f32 v[250:251], v[250:251], v[222:223]
    v_pk_add_f32 v[250:251], v[250:251], v[224:225]
    v_pk_add_f32 v[250:251], v[250:251], v[226:227]
    v_pk_add_f32 v[250:251], v[250:251], v[228:229]
    v_pk_add_f32 v[250:251], v[250:251], v[230:231]
    v_add_f32 v250, v250, v251
    ds_bpermute_b32 v251, v5, v250
    s_waitcnt lgkmcnt(0)
    v_add_f32 v250, v250, v251
    v_rcp_f32 v250, v250
    s_nop 0
    v_mov_b32 v251, v250
    v_pk_mul_f32 v[88:89], v[88:89], v[250:251]
    v_cvt_pk_bf16_f32 v16, v88, v89
    v_pk_mul_f32 v[90:91], v[90:91], v[250:251]
    v_cvt_pk_bf16_f32 v17, v90, v91
    v_pk_mul_f32 v[92:93], v[92:93], v[250:251]
    v_cvt_pk_bf16_f32 v18, v92, v93
    v_pk_mul_f32 v[94:95], v[94:95], v[250:251]
    v_cvt_pk_bf16_f32 v19, v94, v95
    v_pk_mul_f32 v[96:97], v[96:97], v[250:251]
    v_cvt_pk_bf16_f32 v20, v96, v97
    v_pk_mul_f32 v[98:99], v[98:99], v[250:251]
    v_cvt_pk_bf16_f32 v21, v98, v99
    v_pk_mul_f32 v[100:101], v[100:101], v[250:251]
    v_cvt_pk_bf16_f32 v22, v100, v101
    v_pk_mul_f32 v[102:103], v[102:103], v[250:251]
    v_cvt_pk_bf16_f32 v23, v102, v103
    v_pk_mul_f32 v[104:105], v[104:105], v[250:251]
    v_cvt_pk_bf16_f32 v24, v104, v105
    v_pk_mul_f32 v[106:107], v[106:107], v[250:251]
    v_cvt_pk_bf16_f32 v25, v106, v107
    v_pk_mul_f32 v[108:109], v[108:109], v[250:251]
    v_cvt_pk_bf16_f32 v26, v108, v109
    v_pk_mul_f32 v[110:111], v[110:111], v[250:251]
    v_cvt_pk_bf16_f32 v27, v110, v111
    v_pk_mul_f32 v[112:113], v[112:113], v[250:251]
    v_cvt_pk_bf16_f32 v28, v112, v113
    v_pk_mul_f32 v[114:115], v[114:115], v[250:251]
    v_cvt_pk_bf16_f32 v29, v114, v115
    v_pk_mul_f32 v[116:117], v[116:117], v[250:251]
    v_cvt_pk_bf16_f32 v30, v116, v117
    v_pk_mul_f32 v[118:119], v[118:119], v[250:251]
    v_cvt_pk_bf16_f32 v31, v118, v119
    v_pk_mul_f32 v[120:121], v[120:121], v[250:251]
    v_cvt_pk_bf16_f32 v32, v120, v121
    v_pk_mul_f32 v[122:123], v[122:123], v[250:251]
    v_cvt_pk_bf16_f32 v33, v122, v123
    v_pk_mul_f32 v[124:125], v[124:125], v[250:251]
    v_cvt_pk_bf16_f32 v34, v124, v125
    v_pk_mul_f32 v[126:127], v[126:127], v[250:251]
    v_cvt_pk_bf16_f32 v35, v126, v127
    v_pk_mul_f32 v[128:129], v[128:129], v[250:251]
    v_cvt_pk_bf16_f32 v36, v128, v129
    v_pk_mul_f32 v[130:131], v[130:131], v[250:251]
    v_cvt_pk_bf16_f32 v37, v130, v131
    v_pk_mul_f32 v[132:133], v[132:133], v[250:251]
    v_cvt_pk_bf16_f32 v38, v132, v133
    v_pk_mul_f32 v[134:135], v[134:135], v[250:251]
    v_cvt_pk_bf16_f32 v39, v134, v135
    v_pk_mul_f32 v[136:137], v[136:137], v[250:251]
    v_cvt_pk_bf16_f32 v40, v136, v137
    v_pk_mul_f32 v[138:139], v[138:139], v[250:251]
    v_cvt_pk_bf16_f32 v41, v138, v139
    v_pk_mul_f32 v[140:141], v[140:141], v[250:251]
    v_cvt_pk_bf16_f32 v42, v140, v141
    v_pk_mul_f32 v[142:143], v[142:143], v[250:251]
    v_cvt_pk_bf16_f32 v43, v142, v143
    v_pk_mul_f32 v[144:145], v[144:145], v[250:251]
    v_cvt_pk_bf16_f32 v44, v144, v145
    v_pk_mul_f32 v[146:147], v[146:147], v[250:251]
    v_cvt_pk_bf16_f32 v45, v146, v147
    v_pk_mul_f32 v[148:149], v[148:149], v[250:251]
    v_cvt_pk_bf16_f32 v46, v148, v149
    v_pk_mul_f32 v[150:151], v[150:151], v[250:251]
    v_cvt_pk_bf16_f32 v47, v150, v151
    v_pk_mul_f32 v[152:153], v[152:153], v[250:251]
    v_cvt_pk_bf16_f32 v48, v152, v153
    v_pk_mul_f32 v[154:155], v[154:155], v[250:251]
    v_cvt_pk_bf16_f32 v49, v154, v155
    v_pk_mul_f32 v[156:157], v[156:157], v[250:251]
    v_cvt_pk_bf16_f32 v50, v156, v157
    v_pk_mul_f32 v[158:159], v[158:159], v[250:251]
    v_cvt_pk_bf16_f32 v51, v158, v159
    v_pk_mul_f32 v[160:161], v[160:161], v[250:251]
    v_cvt_pk_bf16_f32 v52, v160, v161
    v_pk_mul_f32 v[162:163], v[162:163], v[250:251]
    v_cvt_pk_bf16_f32 v53, v162, v163
    v_pk_mul_f32 v[164:165], v[164:165], v[250:251]
    v_cvt_pk_bf16_f32 v54, v164, v165
    v_pk_mul_f32 v[166:167], v[166:167], v[250:251]
    v_cvt_pk_bf16_f32 v55, v166, v167
    v_pk_mul_f32 v[168:169], v[168:169], v[250:251]
    v_cvt_pk_bf16_f32 v56, v168, v169
    v_pk_mul_f32 v[170:171], v[170:171], v[250:251]
    v_cvt_pk_bf16_f32 v57, v170, v171
    v_pk_mul_f32 v[172:173], v[172:173], v[250:251]
    v_cvt_pk_bf16_f32 v58, v172, v173
    v_pk_mul_f32 v[174:175], v[174:175], v[250:251]
    v_cvt_pk_bf16_f32 v59, v174, v175
    v_pk_mul_f32 v[176:177], v[176:177], v[250:251]
    v_cvt_pk_bf16_f32 v60, v176, v177
    v_pk_mul_f32 v[178:179], v[178:179], v[250:251]
    v_cvt_pk_bf16_f32 v61, v178, v179
    v_pk_mul_f32 v[180:181], v[180:181], v[250:251]
    v_cvt_pk_bf16_f32 v62, v180, v181
    v_pk_mul_f32 v[182:183], v[182:183], v[250:251]
    v_cvt_pk_bf16_f32 v63, v182, v183
    v_pk_mul_f32 v[184:185], v[184:185], v[250:251]
    v_cvt_pk_bf16_f32 v64, v184, v185
    v_pk_mul_f32 v[186:187], v[186:187], v[250:251]
    v_cvt_pk_bf16_f32 v65, v186, v187
    v_pk_mul_f32 v[188:189], v[188:189], v[250:251]
    v_cvt_pk_bf16_f32 v66, v188, v189
    v_pk_mul_f32 v[190:191], v[190:191], v[250:251]
    v_cvt_pk_bf16_f32 v67, v190, v191
    v_pk_mul_f32 v[192:193], v[192:193], v[250:251]
    v_cvt_pk_bf16_f32 v68, v192, v193
    v_pk_mul_f32 v[194:195], v[194:195], v[250:251]
    v_cvt_pk_bf16_f32 v69, v194, v195
    v_pk_mul_f32 v[196:197], v[196:197], v[250:251]
    v_cvt_pk_bf16_f32 v70, v196, v197
    v_pk_mul_f32 v[198:199], v[198:199], v[250:251]
    v_cvt_pk_bf16_f32 v71, v198, v199
    v_pk_mul_f32 v[200:201], v[200:201], v[250:251]
    v_cvt_pk_bf16_f32 v72, v200, v201
    v_pk_mul_f32 v[202:203], v[202:203], v[250:251]
    v_cvt_pk_bf16_f32 v73, v202, v203
    v_pk_mul_f32 v[204:205], v[204:205], v[250:251]
    v_cvt_pk_bf16_f32 v74, v204, v205
    v_pk_mul_f32 v[206:207], v[206:207], v[250:251]
    v_cvt_pk_bf16_f32 v75, v206, v207
    v_pk_mul_f32 v[208:209], v[208:209], v[250:251]
    v_cvt_pk_bf16_f32 v76, v208, v209
    v_pk_mul_f32 v[210:211], v[210:211], v[250:251]
    v_cvt_pk_bf16_f32 v77, v210, v211
    v_pk_mul_f32 v[212:213], v[212:213], v[250:251]
    v_cvt_pk_bf16_f32 v78, v212, v213
    v_pk_mul_f32 v[214:215], v[214:215], v[250:251]
    v_cvt_pk_bf16_f32 v79, v214, v215
    v_pk_mul_f32 v[216:217], v[216:217], v[250:251]
    v_cvt_pk_bf16_f32 v80, v216, v217
    v_pk_mul_f32 v[218:219], v[218:219], v[250:251]
    v_cvt_pk_bf16_f32 v81, v218, v219
    v_pk_mul_f32 v[220:221], v[220:221], v[250:251]
    v_cvt_pk_bf16_f32 v82, v220, v221
    v_pk_mul_f32 v[222:223], v[222:223], v[250:251]
    v_cvt_pk_bf16_f32 v83, v222, v223
    v_pk_mul_f32 v[224:225], v[224:225], v[250:251]
    v_cvt_pk_bf16_f32 v84, v224, v225
    v_pk_mul_f32 v[226:227], v[226:227], v[250:251]
    v_cvt_pk_bf16_f32 v85, v226, v227
    v_pk_mul_f32 v[228:229], v[228:229], v[250:251]
    v_cvt_pk_bf16_f32 v86, v228, v229
    v_pk_mul_f32 v[230:231], v[230:231], v[250:251]
    v_cvt_pk_bf16_f32 v87, v230, v231
    v_bfe_u32 v248, v2, 2, 2
    v_lshl_add_u32 v248, v4, 2, v248
    s_lshl_b32 s35, s20, 5
    v_add_u32 v248, s35, v248
    v_lshlrev_b32 v248, 6, v248
    v_bfe_u32 v249, v2, 4, 1
    v_lshl_add_u32 v248, v249, 5, v248
    v_and_b32 v249, 3, v2
    v_lshl_add_u32 v6, v249, 3, v248
    s_barrier
    ds_read_b64_tr_b16 v[248:249], v6 offset:0
    ds_read_b64_tr_b16 v[250:251], v6 offset:512
    ds_read_b64_tr_b16 v[252:253], v6 offset:1024
    ds_read_b64_tr_b16 v[254:255], v6 offset:1536
    s_waitcnt lgkmcnt(2)
    v_mfma_f32_32x32x16_bf16 v[232:247], v[248:251], v[16:19], v[232:247]
    ds_read_b64_tr_b16 v[248:249], v6 offset:2048
    ds_read_b64_tr_b16 v[250:251], v6 offset:2560
    s_waitcnt lgkmcnt(2)
    v_mfma_f32_32x32x16_bf16 v[232:247], v[252:255], v[20:23], v[232:247]
    ds_read_b64_tr_b16 v[252:253], v6 offset:3072
    ds_read_b64_tr_b16 v[254:255], v6 offset:3584
    s_waitcnt lgkmcnt(2)
    v_mfma_f32_32x32x16_bf16 v[232:247], v[248:251], v[24:27], v[232:247]
    ds_read_b64_tr_b16 v[248:249], v6 offset:4096
    ds_read_b64_tr_b16 v[250:251], v6 offset:4608
    s_waitcnt lgkmcnt(2)
    v_mfma_f32_32x32x16_bf16 v[232:247], v[252:255], v[28:31], v[232:247]
    ds_read_b64_tr_b16 v[252:253], v6 offset:5120
    ds_read_b64_tr_b16 v[254:255], v6 offset:5632
    s_waitcnt lgkmcnt(2)
    v_mfma_f32_32x32x16_bf16 v[232:247], v[248:251], v[32:35], v[232:247]
    ds_read_b64_tr_b16 v[248:249], v6 offset:6144
    ds_read_b64_tr_b16 v[250:251], v6 offset:6656
    s_waitcnt lgkmcnt(2)
    v_mfma_f32_32x32x16_bf16 v[232:247], v[252:255], v[36:39], v[232:247]
    ds_read_b64_tr_b16 v[252:253], v6 offset:7168
    ds_read_b64_tr_b16 v[254:255], v6 offset:7680
    s_waitcnt lgkmcnt(2)
    v_mfma_f32_32x32x16_bf16 v[232:247], v[248:251], v[40:43], v[232:247]
    ds_read_b64_tr_b16 v[248:249], v6 offset:8192
    ds_read_b64_tr_b16 v[250:251], v6 offset:8704
    s_waitcnt lgkmcnt(2)
    v_mfma_f32_32x32x16_bf16 v[232:247], v[252:255], v[44:47], v[232:247]
    ds_read_b64_tr_b16 v[252:253], v6 offset:9216
    ds_read_b64_tr_b16 v[254:255], v6 offset:9728
    s_waitcnt lgkmcnt(2)
    v_mfma_f32_32x32x16_bf16 v[232:247], v[248:251], v[48:51], v[232:247]
    ds_read_b64_tr_b16 v[248:249], v6 offset:10240
    ds_read_b64_tr_b16 v[250:251], v6 offset:10752
    s_waitcnt lgkmcnt(2)
    v_mfma_f32_32x32x16_bf16 v[232:247], v[252:255], v[52:55], v[232:247]
    ds_read_b64_tr_b16 v[252:253], v6 offset:11264
    ds_read_b64_tr_b16 v[254:255], v6 offset:11776
    s_waitcnt lgkmcnt(2)
    v_mfma_f32_32x32x16_bf16 v[232:247], v[248:251], v[56:59], v[232:247]
    ds_read_b64_tr_b16 v[248:249], v6 offset:12288
    ds_read_b64_tr_b16 v[250:251], v6 offset:12800
    s_waitcnt lgkmcnt(2)
    v_mfma_f32_32x32x16_bf16 v[232:247], v[252:255], v[60:63], v[232:247]
    ds_read_b64_tr_b16 v[252:253], v6 offset:13312
    ds_read_b64_tr_b16 v[254:255], v6 offset:13824
    s_waitcnt lgkmcnt(2)
    v_mfma_f32_32x32x16_bf16 v[232:247], v[248:251], v[64:67], v[232:247]
    ds_read_b64_tr_b16 v[248:249], v6 offset:14336
    ds_read_b64_tr_b16 v[250:251], v6 offset:14848
    s_waitcnt lgkmcnt(2)
    v_mfma_f32_32x32x16_bf16 v[232:247], v[252:255], v[68:71], v[232:247]
    ds_read_b64_tr_b16 v[252:253], v6 offset:15360
    ds_read_b64_tr_b16 v[254:255], v6 offset:15872
    s_waitcnt lgkmcnt(2)
    v_mfma_f32_32x32x16_bf16 v[232:247], v[248:251], v[72:75], v[232:247]
    ds_read_b64_tr_b16 v[248:249], v6 offset:16384
    ds_read_b64_tr_b16 v[250:251], v6 offset:16896
    s_waitcnt lgkmcnt(2)
    v_mfma_f32_32x32x16_bf16 v[232:247], v[252:255], v[76:79], v[232:247]
    ds_read_b64_tr_b16 v[252:253], v6 offset:17408
    ds_read_b64_tr_b16 v[254:255], v6 offset:17920
    s_waitcnt lgkmcnt(2)
    v_mfma_f32_32x32x16_bf16 v[232:247], v[248:251], v[80:83], v[232:247]
    s_waitcnt lgkmcnt(0)
    v_mfma_f32_32x32x16_bf16 v[232:247], v[252:255], v[84:87], v[232:247]
    s_nop 15
    s_nop 7
    s_add_u32 s8, s26, 16777216
    s_addc_u32 s9, s27, 0
    s_mov_b32 s10, 18874368
    s_lshr_b32 s35, s32, 8
    s_mul_i32 s35, s35, 144
    s_add_u32 s35, s35, s30
    s_lshl_b32 s35, s35, 14
    s_and_b32 s36, s32, 255
    s_lshl_b32 s36, s36, 6
    s_add_u32 s35, s35, s36
    v_lshlrev_b32 v6, 6, v3
    v_lshl_add_u32 v6, v4, 3, v6
    v_add_u32 v6, s35, v6
    v_bfe_u32 v7, v3, 2, 2
    v_xor_b32 v250, 0, v7
    v_lshl_add_u32 v250, v250, 4, v6
    v_cvt_pk_bf16_f32 v248, v232, v233
    v_cvt_pk_bf16_f32 v249, v234, v235
    buffer_store_dwordx2 v[248:249], v250, s[8:11], 0 offen
    s_nop 1
    v_xor_b32 v250, 1, v7
    v_lshl_add_u32 v250, v250, 4, v6
    v_cvt_pk_bf16_f32 v248, v236, v237
    v_cvt_pk_bf16_f32 v249, v238, v239
    buffer_store_dwordx2 v[248:249], v250, s[8:11], 0 offen
    s_nop 1
    v_xor_b32 v250, 2, v7
    v_lshl_add_u32 v250, v250, 4, v6
    v_cvt_pk_bf16_f32 v248, v240, v241
    v_cvt_pk_bf16_f32 v249, v242, v243
    buffer_store_dwordx2 v[248:249], v250, s[8:11], 0 offen
    s_nop 1
    v_xor_b32 v250, 3, v7
    v_lshl_add_u32 v250, v250, 4, v6
    v_cvt_pk_bf16_f32 v248, v244, v245
    v_cvt_pk_bf16_f32 v249, v246, v247
    buffer_store_dwordx2 v[248:249], v250, s[8:11], 0 offen
    s_nop 1
L_attn_done:
    s_endpgm
.globl gemm2_kernel
.p2align 8
.type gemm2_kernel,@function
gemm2_kernel:
    s_cmp_ge_u32 s2, 256
    s_cbranch_scc1 L_g2_done
    s_load_dwordx2 s[4:5], s[0:1], 16
    s_load_dwordx2 s[6:7], s[0:1], 48
    s_load_dwordx2 s[26:27], s[0:1], 72
    v_lshrrev_b32 v1, 6, v0
    v_and_b32 v2, 63, v0
    s_nop 0
    v_readfirstlane_b32 s20, v1
    s_bfe_u32 s38, s2, 0x20001
    s_and_b32 s30, s2, 1
    s_lshl_b32 s30, s30, 2
    s_bfe_u32 s31, s2, 0x20003
    s_add_u32 s30, s30, s31
    s_lshr_b32 s31, s2, 5
    s_waitcnt lgkmcnt(0)
    s_add_u32 s8, s26, 16777216
    s_addc_u32 s9, s27, 0
    s_mov_b32 s10, 18874368
    s_mov_b32 s11, 0x00020000
    s_mul_i32 s16, s30, 144
    s_mul_i32 s18, s38, 36
    s_add_u32 s16, s16, s18
    s_lshl_b32 s16, s16, 14
    s_lshr_b32 s21, s20, 2
    s_lshl_b32 s18, s31, 8
    s_lshl_b32 s19, s21, 7
    s_add_u32 s18, s18, s19
    s_add_u32 s12, s4, s18
    s_addc_u32 s13, s5, 0
    s_sub_u32 s14, 2097152, s18
    s_add_u32 s32, s6, s18
    s_addc_u32 s33, s7, 0
    s_sub_u32 s34, 7340032, s18
    s_mov_b32 s15, 0x00020000
    s_mov_b32 s17, 0
    s_mov_b32 s39, 0
    s_cmp_eq_u32 s38, 0
    s_cbranch_scc1 L_g2_k0
    s_mul_i32 s19, s38, 36
    s_sub_u32 s19, s19, 32
    s_lshl_b32 s19, s19, 16
    s_add_u32 s12, s32, s19
    s_addc_u32 s13, s33, 0
    s_sub_u32 s14, s34, s19
    s_movk_i32 s39, 1000
L_g2_k0:
    s_lshl_b32 s35, s20, 11
    v_lshl_add_u32 v4, v2, 4, s35
    v_lshrrev_b32 v18, 3, v2
    v_and_b32 v19, 7, v2
    v_lshrrev_b32 v20, 4, v2
    s_and_b32 s35, s20, 3
    s_lshl_b32 s35, s35, 3
    v_add_u32 v21, s35, v18
    v_lshlrev_b32 v21, 11, v21
    v_and_b32 v22, 1, v20
    v_lshlrev_b32 v22, 2, v22
    v_xor_b32 v22, v22, v19
    v_lshl_add_u32 v5, v22, 4, v21
    v_and_b32 v18, 31, v2
    v_lshrrev_b32 v19, 5, v2
    s_lshr_b32 s35, s20, 1
    s_lshl_b32 s35, s35, 6
    v_add_u32 v20, s35, v18
    v_lshlrev_b32 v20, 6, v20
    v_bfe_u32 v21, v18, 2, 2
    v_or_b32 v22, 0, v19
    v_xor_b32 v22, v22, v21
    v_lshl_add_u32 v6, v22, 4, v20
    v_add_u32 v8, 49152, v6
    v_add_u32 v10, 98304, v6
    v_or_b32 v22, 2, v19
    v_xor_b32 v22, v22, v21
    v_lshl_add_u32 v7, v22, 4, v20
    v_add_u32 v9, 49152, v7
    v_add_u32 v11, 98304, v7
    v_bfe_u32 v18, v2, 2, 2
    v_lshrrev_b32 v19, 5, v2
    v_lshl_add_u32 v19, v19, 3, v18
    v_lshlrev_b32 v19, 7, v19
    v_and_b32 v21, 1, v2
    v_lshl_add_u32 v19, v21, 3, v19
    v_add_u32 v19, 32768, v19
    v_bfe_u32 v20, v2, 4, 1
    v_bfe_u32 v21, v2, 1, 1
    v_lshl_add_u32 v20, v20, 1, v21
    v_bfe_u32 v21, v2, 3, 1
    v_lshlrev_b32 v21, 2, v21
    s_and_b32 s35, s20, 1
    s_lshl_b32 s36, s35, 12
    v_or_b32 v22, 0, v20
    v_xor_b32 v22, v22, v21
    v_lshl_add_u32 v12, v22, 4, v19
    v_add_u32 v12, s36, v12
    v_add_u32 v14, 49152, v12
    v_add_u32 v16, 98304, v12
    v_or_b32 v22, 4, v20
    v_xor_b32 v22, v22, v21
    v_lshl_add_u32 v13, v22, 4, v19
    v_add_u32 v13, s36, v13
    v_add_u32 v15, 49152, v13
    v_add_u32 v17, 98304, v13
    v_mov_b32 v56, 0
    v_mov_b32 v57, 0
    v_mov_b32 v58, 0
    v_mov_b32 v59, 0
    v_mov_b32 v60, 0
    v_mov_b32 v61, 0
    v_mov_b32 v62, 0
    v_mov_b32 v63, 0
    v_mov_b32 v64, 0
    v_mov_b32 v65, 0
    v_mov_b32 v66, 0
    v_mov_b32 v67, 0
    v_mov_b32 v68, 0
    v_mov_b32 v69, 0
    v_mov_b32 v70, 0
    v_mov_b32 v71, 0
    v_mov_b32 v72, 0
    v_mov_b32 v73, 0
    v_mov_b32 v74, 0
    v_mov_b32 v75, 0
    v_mov_b32 v76, 0
    v_mov_b32 v77, 0
    v_mov_b32 v78, 0
    v_mov_b32 v79, 0
    v_mov_b32 v80, 0
    v_mov_b32 v81, 0
    v_mov_b32 v82, 0
    v_mov_b32 v83, 0
    v_mov_b32 v84, 0
    v_mov_b32 v85, 0
    v_mov_b32 v86, 0
    v_mov_b32 v87, 0
    v_mov_b32 v88, 0
    v_mov_b32 v89, 0
    v_mov_b32 v90, 0
    v_mov_b32 v91, 0
    v_mov_b32 v92, 0
    v_mov_b32 v93, 0
    v_mov_b32 v94, 0
    v_mov_b32 v95, 0
    v_mov_b32 v96, 0
    v_mov_b32 v97, 0
    v_mov_b32 v98, 0
    v_mov_b32 v99, 0
    v_mov_b32 v100, 0
    v_mov_b32 v101, 0
    v_mov_b32 v102, 0
    v_mov_b32 v103, 0
    v_mov_b32 v104, 0
    v_mov_b32 v105, 0
    v_mov_b32 v106, 0
    v_mov_b32 v107, 0
    v_mov_b32 v108, 0
    v_mov_b32 v109, 0
    v_mov_b32 v110, 0
    v_mov_b32 v111, 0
    v_mov_b32 v112, 0
    v_mov_b32 v113, 0
    v_mov_b32 v114, 0
    v_mov_b32 v115, 0
    v_mov_b32 v116, 0
    v_mov_b32 v117, 0
    v_mov_b32 v118, 0
    v_mov_b32 v119, 0
    s_lshl_b32 s22, s20, 11
    s_and_b32 s35, s20, 3
    s_lshl_b32 s23, s35, 10
    s_lshl_b32 s35, s21, 12
    s_add_u32 s23, s23, s35
    s_add_u32 m0, s22, 0
    s_nop 0
    buffer_load_dwordx4 v4, s[8:11], s16 offen lds
    buffer_load_dwordx4 v4, s[8:11], s16 offen offset:1024 lds
    s_add_u32 m0, s23, 32768
    s_add_u32 s16, s16, 16384
    buffer_load_dwordx4 v5, s[12:15], s17 offen lds
    s_add_u32 s17, s17, 65536
    s_add_u32 s39, s39, 1
    s_cmp_eq_u32 s39, 32
    s_cselect_b32 s12, s32, s12
    s_cselect_b32 s13, s33, s13
    s_cselect_b32 s14, s34, s14
    s_cselect_b32 s17, 0, s17
    s_add_u32 m0, s22, 16384
    s_nop 0
    buffer_load_dwordx4 v4, s[8:11], s16 offen lds
    buffer_load_dwordx4 v4, s[8:11], s16 offen offset:1024 lds
    s_add_u32 m0, s23, 40960
    s_add_u32 s16, s16, 16384
    buffer_load_dwordx4 v5, s[12:15], s17 offen lds
    s_add_u32 s17, s17, 65536
    s_add_u32 s39, s39, 1
    s_cmp_eq_u32 s39, 32
    s_cselect_b32 s12, s32, s12
    s_cselect_b32 s13, s33, s13
    s_cselect_b32 s14, s34, s14
    s_cselect_b32 s17, 0, s17
    s_add_u32 m0, s22, 49152
    s_nop 0
    buffer_load_dwordx4 v4, s[8:11], s16 offen lds
    buffer_load_dwordx4 v4, s[8:11], s16 offen offset:1024 lds
    s_add_u32 m0, s23, 81920
    s_add_u32 s16, s16, 16384
    buffer_load_dwordx4 v5, s[12:15], s17 offen lds
    s_add_u32 s17, s17, 65536
    s_add_u32 s39, s39, 1
    s_cmp_eq_u32 s39, 32
    s_cselect_b32 s12, s32, s12
    s_cselect_b32 s13, s33, s13
    s_cselect_b32 s14, s34, s14
    s_cselect_b32 s17, 0, s17
    s_add_u32 m0, s22, 65536
    s_nop 0
    buffer_load_dwordx4 v4, s[8:11], s16 offen lds
    buffer_load_dwordx4 v4, s[8:11], s16 offen offset:1024 lds
    s_add_u32 m0, s23, 90112
    s_add_u32 s16, s16, 16384
    buffer_load_dwordx4 v5, s[12:15], s17 offen lds
    s_add_u32 s17, s17, 65536
    s_add_u32 s39, s39, 1
    s_cmp_eq_u32 s39, 32
    s_cselect_b32 s12, s32, s12
    s_cselect_b32 s13, s33, s13
    s_cselect_b32 s14, s34, s14
    s_cselect_b32 s17, 0, s17
    s_waitcnt vmcnt(6)
    s_barrier
    s_movk_i32 s37, 5
L_g2_loop:
    ds_read_b64_tr_b16 v[24:25], v12 offset:0
    ds_read_b64_tr_b16 v[26:27], v12 offset:512
    ds_read_b64_tr_b16 v[28:29], v13 offset:0
    ds_read_b64_tr_b16 v[30:31], v13 offset:512
    ds_read_b128 v[32:35], v6 offset:0
    ds_read_b128 v[36:39], v6 offset:2048
    ds_read_b64_tr_b16 v[40:41], v12 offset:2048
    ds_read_b64_tr_b16 v[42:43], v12 offset:2560
    ds_read_b64_tr_b16 v[44:45], v13 offset:2048
    ds_read_b64_tr_b16 v[46:47], v13 offset:2560
    ds_read_b128 v[48:51], v7 offset:0
    ds_read_b128 v[52:55], v7 offset:2048
    s_waitcnt lgkmcnt(6)
    v_mfma_f32_32x32x16_bf16 v[56:71], v[24:27], v[32:35], v[56:71]
    v_mfma_f32_32x32x16_bf16 v[72:87], v[24:27], v[36:39], v[72:87]
    v_mfma_f32_32x32x16_bf16 v[88:103], v[28:31], v[32:35], v[88:103]
    v_mfma_f32_32x32x16_bf16 v[104:119], v[28:31], v[36:39], v[104:119]
    s_add_u32 m0, s22, 98304
    s_nop 0
    buffer_load_dwordx4 v4, s[8:11], s16 offen lds
    buffer_load_dwordx4 v4, s[8:11], s16 offen offset:1024 lds
    s_add_u32 m0, s23, 131072
    s_add_u32 s16, s16, 16384
    buffer_load_dwordx4 v5, s[12:15], s17 offen lds
    s_add_u32 s17, s17, 65536
    s_add_u32 s39, s39, 1
    s_cmp_eq_u32 s39, 32
    s_cselect_b32 s12, s32, s12
    s_cselect_b32 s13, s33, s13
    s_cselect_b32 s14, s34, s14
    s_cselect_b32 s17, 0, s17
    ds_read_b64_tr_b16 v[24:25], v12 offset:8192
    ds_read_b64_tr_b16 v[26:27], v12 offset:8704
    ds_read_b64_tr_b16 v[28:29], v13 offset:8192
    ds_read_b64_tr_b16 v[30:31], v13 offset:8704
    ds_read_b128 v[32:35], v6 offset:16384
    ds_read_b128 v[36:39], v6 offset:18432
    s_waitcnt lgkmcnt(6)
    v_mfma_f32_32x32x16_bf16 v[56:71], v[40:43], v[48:51], v[56:71]
    v_mfma_f32_32x32x16_bf16 v[72:87], v[40:43], v[52:55], v[72:87]
    v_mfma_f32_32x32x16_bf16 v[88:103], v[44:47], v[48:51], v[88:103]
    v_mfma_f32_32x32x16_bf16 v[104:119], v[44:47], v[52:55], v[104:119]
    s_add_u32 m0, s22, 114688
    s_nop 0
    buffer_load_dwordx4 v4, s[8:11], s16 offen lds
    buffer_load_dwordx4 v4, s[8:11], s16 offen offset:1024 lds
    s_add_u32 m0, s23, 139264
    s_add_u32 s16, s16, 16384
    buffer_load_dwordx4 v5, s[12:15], s17 offen lds
    s_add_u32 s17, s17, 65536
    s_add_u32 s39, s39, 1
    s_cmp_eq_u32 s39, 32
    s_cselect_b32 s12, s32, s12
    s_cselect_b32 s13, s33, s13
    s_cselect_b32 s14, s34, s14
    s_cselect_b32 s17, 0, s17
    ds_read_b64_tr_b16 v[40:41], v12 offset:10240
    ds_read_b64_tr_b16 v[42:43], v12 offset:10752
    ds_read_b64_tr_b16 v[44:45], v13 offset:10240
    ds_read_b64_tr_b16 v[46:47], v13 offset:10752
    ds_read_b128 v[48:51], v7 offset:16384
    ds_read_b128 v[52:55], v7 offset:18432
    s_waitcnt lgkmcnt(6)
    v_mfma_f32_32x32x16_bf16 v[56:71], v[24:27], v[32:35], v[56:71]
    v_mfma_f32_32x32x16_bf16 v[72:87], v[24:27], v[36:39], v[72:87]
    v_mfma_f32_32x32x16_bf16 v[88:103], v[28:31], v[32:35], v[88:103]
    v_mfma_f32_32x32x16_bf16 v[104:119], v[28:31], v[36:39], v[104:119]
    s_waitcnt lgkmcnt(0)
    v_mfma_f32_32x32x16_bf16 v[56:71], v[40:43], v[48:51], v[56:71]
    v_mfma_f32_32x32x16_bf16 v[72:87], v[40:43], v[52:55], v[72:87]
    v_mfma_f32_32x32x16_bf16 v[88:103], v[44:47], v[48:51], v[88:103]
    v_mfma_f32_32x32x16_bf16 v[104:119], v[44:47], v[52:55], v[104:119]
    s_waitcnt vmcnt(6)
    s_barrier
    ds_read_b64_tr_b16 v[24:25], v14 offset:0
    ds_read_b64_tr_b16 v[26:27], v14 offset:512
    ds_read_b64_tr_b16 v[28:29], v15 offset:0
    ds_read_b64_tr_b16 v[30:31], v15 offset:512
    ds_read_b128 v[32:35], v8 offset:0
    ds_read_b128 v[36:39], v8 offset:2048
    ds_read_b64_tr_b16 v[40:41], v14 offset:2048
    ds_read_b64_tr_b16 v[42:43], v14 offset:2560
    ds_read_b64_tr_b16 v[44:45], v15 offset:2048
    ds_read_b64_tr_b16 v[46:47], v15 offset:2560
    ds_read_b128 v[48:51], v9 offset:0
    ds_read_b128 v[52:55], v9 offset:2048
    s_waitcnt lgkmcnt(6)
    v_mfma_f32_32x32x16_bf16 v[56:71], v[24:27], v[32:35], v[56:71]
    v_mfma_f32_32x32x16_bf16 v[72:87], v[24:27], v[36:39], v[72:87]
    v_mfma_f32_32x32x16_bf16 v[88:103], v[28:31], v[32:35], v[88:103]
    v_mfma_f32_32x32x16_bf16 v[104:119], v[28:31], v[36:39], v[104:119]
    s_add_u32 m0, s22, 0
    s_nop 0
    buffer_load_dwordx4 v4, s[8:11], s16 offen lds
    buffer_load_dwordx4 v4, s[8:11], s16 offen offset:1024 lds
    s_add_u32 m0, s23, 32768
    s_add_u32 s16, s16, 16384
    buffer_load_dwordx4 v5, s[12:15], s17 offen lds
    s_add_u32 s17, s17, 65536
    s_add_u32 s39, s39, 1
    s_cmp_eq_u32 s39, 32
    s_cselect_b32 s12, s32, s12
    s_cselect_b32 s13, s33, s13
    s_cselect_b32 s14, s34, s14
    s_cselect_b32 s17, 0, s17
    ds_read_b64_tr_b16 v[24:25], v14 offset:8192
    ds_read_b64_tr_b16 v[26:27], v14 offset:8704
    ds_read_b64_tr_b16 v[28:29], v15 offset:8192
    ds_read_b64_tr_b16 v[30:31], v15 offset:8704
    ds_read_b128 v[32:35], v8 offset:16384
    ds_read_b128 v[36:39], v8 offset:18432
    s_waitcnt lgkmcnt(6)
    v_mfma_f32_32x32x16_bf16 v[56:71], v[40:43], v[48:51], v[56:71]
    v_mfma_f32_32x32x16_bf16 v[72:87], v[40:43], v[52:55], v[72:87]
    v_mfma_f32_32x32x16_bf16 v[88:103], v[44:47], v[48:51], v[88:103]
    v_mfma_f32_32x32x16_bf16 v[104:119], v[44:47], v[52:55], v[104:119]
    s_add_u32 m0, s22, 16384
    s_nop 0
    buffer_load_dwordx4 v4, s[8:11], s16 offen lds
    buffer_load_dwordx4 v4, s[8:11], s16 offen offset:1024 lds
    s_add_u32 m0, s23, 40960
    s_add_u32 s16, s16, 16384
    buffer_load_dwordx4 v5, s[12:15], s17 offen lds
    s_add_u32 s17, s17, 65536
    s_add_u32 s39, s39, 1
    s_cmp_eq_u32 s39, 32
    s_cselect_b32 s12, s32, s12
    s_cselect_b32 s13, s33, s13
    s_cselect_b32 s14, s34, s14
    s_cselect_b32 s17, 0, s17
    ds_read_b64_tr_b16 v[40:41], v14 offset:10240
    ds_read_b64_tr_b16 v[42:43], v14 offset:10752
    ds_read_b64_tr_b16 v[44:45], v15 offset:10240
    ds_read_b64_tr_b16 v[46:47], v15 offset:10752
    ds_read_b128 v[48:51], v9 offset:16384
    ds_read_b128 v[52:55], v9 offset:18432
    s_waitcnt lgkmcnt(6)
    v_mfma_f32_32x32x16_bf16 v[56:71], v[24:27], v[32:35], v[56:71]
    v_mfma_f32_32x32x16_bf16 v[72:87], v[24:27], v[36:39], v[72:87]
    v_mfma_f32_32x32x16_bf16 v[88:103], v[28:31], v[32:35], v[88:103]
    v_mfma_f32_32x32x16_bf16 v[104:119], v[28:31], v[36:39], v[104:119]
    s_waitcnt lgkmcnt(0)
    v_mfma_f32_32x32x16_bf16 v[56:71], v[40:43], v[48:51], v[56:71]
    v_mfma_f32_32x32x16_bf16 v[72:87], v[40:43], v[52:55], v[72:87]
    v_mfma_f32_32x32x16_bf16 v[88:103], v[44:47], v[48:51], v[88:103]
    v_mfma_f32_32x32x16_bf16 v[104:119], v[44:47], v[52:55], v[104:119]
    s_waitcnt vmcnt(6)
    s_barrier
    ds_read_b64_tr_b16 v[24:25], v16 offset:0
    ds_read_b64_tr_b16 v[26:27], v16 offset:512
    ds_read_b64_tr_b16 v[28:29], v17 offset:0
    ds_read_b64_tr_b16 v[30:31], v17 offset:512
    ds_read_b128 v[32:35], v10 offset:0
    ds_read_b128 v[36:39], v10 offset:2048
    ds_read_b64_tr_b16 v[40:41], v16 offset:2048
    ds_read_b64_tr_b16 v[42:43], v16 offset:2560
    ds_read_b64_tr_b16 v[44:45], v17 offset:2048
    ds_read_b64_tr_b16 v[46:47], v17 offset:2560
    ds_read_b128 v[48:51], v11 offset:0
    ds_read_b128 v[52:55], v11 offset:2048
    s_waitcnt lgkmcnt(6)
    v_mfma_f32_32x32x16_bf16 v[56:71], v[24:27], v[32:35], v[56:71]
    v_mfma_f32_32x32x16_bf16 v[72:87], v[24:27], v[36:39], v[72:87]
    v_mfma_f32_32x32x16_bf16 v[88:103], v[28:31], v[32:35], v[88:103]
    v_mfma_f32_32x32x16_bf16 v[104:119], v[28:31], v[36:39], v[104:119]
    s_add_u32 m0, s22, 49152
    s_nop 0
    buffer_load_dwordx4 v4, s[8:11], s16 offen lds
    buffer_load_dwordx4 v4, s[8:11], s16 offen offset:1024 lds
    s_add_u32 m0, s23, 81920
    s_add_u32 s16, s16, 16384
    buffer_load_dwordx4 v5, s[12:15], s17 offen lds
    s_add_u32 s17, s17, 65536
    s_add_u32 s39, s39, 1
    s_cmp_eq_u32 s39, 32
    s_cselect_b32 s12, s32, s12
    s_cselect_b32 s13, s33, s13
    s_cselect_b32 s14, s34, s14
    s_cselect_b32 s17, 0, s17
    ds_read_b64_tr_b16 v[24:25], v16 offset:8192
    ds_read_b64_tr_b16 v[26:27], v16 offset:8704
    ds_read_b64_tr_b16 v[28:29], v17 offset:8192
    ds_read_b64_tr_b16 v[30:31], v17 offset:8704
    ds_read_b128 v[32:35], v10 offset:16384
    ds_read_b128 v[36:39], v10 offset:18432
    s_waitcnt lgkmcnt(6)
    v_mfma_f32_32x32x16_bf16 v[56:71], v[40:43], v[48:51], v[56:71]
    v_mfma_f32_32x32x16_bf16 v[72:87], v[40:43], v[52:55], v[72:87]
    v_mfma_f32_32x32x16_bf16 v[88:103], v[44:47], v[48:51], v[88:103]
    v_mfma_f32_32x32x16_bf16 v[104:119], v[44:47], v[52:55], v[104:119]
    s_add_u32 m0, s22, 65536
    s_nop 0
    buffer_load_dwordx4 v4, s[8:11], s16 offen lds
    buffer_load_dwordx4 v4, s[8:11], s16 offen offset:1024 lds
    s_add_u32 m0, s23, 90112
    s_add_u32 s16, s16, 16384
    buffer_load_dwordx4 v5, s[12:15], s17 offen lds
    s_add_u32 s17, s17, 65536
    s_add_u32 s39, s39, 1
    s_cmp_eq_u32 s39, 32
    s_cselect_b32 s12, s32, s12
    s_cselect_b32 s13, s33, s13
    s_cselect_b32 s14, s34, s14
    s_cselect_b32 s17, 0, s17
    ds_read_b64_tr_b16 v[40:41], v16 offset:10240
    ds_read_b64_tr_b16 v[42:43], v16 offset:10752
    ds_read_b64_tr_b16 v[44:45], v17 offset:10240
    ds_read_b64_tr_b16 v[46:47], v17 offset:10752
    ds_read_b128 v[48:51], v11 offset:16384
    ds_read_b128 v[52:55], v11 offset:18432
    s_waitcnt lgkmcnt(6)
    v_mfma_f32_32x32x16_bf16 v[56:71], v[24:27], v[32:35], v[56:71]
    v_mfma_f32_32x32x16_bf16 v[72:87], v[24:27], v[36:39], v[72:87]
    v_mfma_f32_32x32x16_bf16 v[88:103], v[28:31], v[32:35], v[88:103]
    v_mfma_f32_32x32x16_bf16 v[104:119], v[28:31], v[36:39], v[104:119]
    s_waitcnt lgkmcnt(0)
    v_mfma_f32_32x32x16_bf16 v[56:71], v[40:43], v[48:51], v[56:71]
    v_mfma_f32_32x32x16_bf16 v[72:87], v[40:43], v[52:55], v[72:87]
    v_mfma_f32_32x32x16_bf16 v[88:103], v[44:47], v[48:51], v[88:103]
    v_mfma_f32_32x32x16_bf16 v[104:119], v[44:47], v[52:55], v[104:119]
    s_waitcnt vmcnt(6)
    s_barrier
    s_sub_u32 s37, s37, 1
    s_cmp_lg_u32 s37, 0
    s_cbranch_scc1 L_g2_loop
    ds_read_b64_tr_b16 v[24:25], v12 offset:0
    ds_read_b64_tr_b16 v[26:27], v12 offset:512
    ds_read_b64_tr_b16 v[28:29], v13 offset:0
    ds_read_b64_tr_b16 v[30:31], v13 offset:512
    ds_read_b128 v[32:35], v6 offset:0
    ds_read_b128 v[36:39], v6 offset:2048
    ds_read_b64_tr_b16 v[40:41], v12 offset:2048
    ds_read_b64_tr_b16 v[42:43], v12 offset:2560
    ds_read_b64_tr_b16 v[44:45], v13 offset:2048
    ds_read_b64_tr_b16 v[46:47], v13 offset:2560
    ds_read_b128 v[48:51], v7 offset:0
    ds_read_b128 v[52:55], v7 offset:2048
    s_waitcnt lgkmcnt(6)
    v_mfma_f32_32x32x16_bf16 v[56:71], v[24:27], v[32:35], v[56:71]
    v_mfma_f32_32x32x16_bf16 v[72:87], v[24:27], v[36:39], v[72:87]
    v_mfma_f32_32x32x16_bf16 v[88:103], v[28:31], v[32:35], v[88:103]
    v_mfma_f32_32x32x16_bf16 v[104:119], v[28:31], v[36:39], v[104:119]
    s_add_u32 m0, s22, 98304
    s_nop 0
    buffer_load_dwordx4 v4, s[8:11], s16 offen lds
    buffer_load_dwordx4 v4, s[8:11], s16 offen offset:1024 lds
    s_add_u32 m0, s23, 131072
    s_add_u32 s16, s16, 16384
    buffer_load_dwordx4 v5, s[12:15], s17 offen lds
    s_add_u32 s17, s17, 65536
    s_add_u32 s39, s39, 1
    s_cmp_eq_u32 s39, 32
    s_cselect_b32 s12, s32, s12
    s_cselect_b32 s13, s33, s13
    s_cselect_b32 s14, s34, s14
    s_cselect_b32 s17, 0, s17
    ds_read_b64_tr_b16 v[24:25], v12 offset:8192
    ds_read_b64_tr_b16 v[26:27], v12 offset:8704
    ds_read_b64_tr_b16 v[28:29], v13 offset:8192
    ds_read_b64_tr_b16 v[30:31], v13 offset:8704
    ds_read_b128 v[32:35], v6 offset:16384
    ds_read_b128 v[36:39], v6 offset:18432
    s_waitcnt lgkmcnt(6)
    v_mfma_f32_32x32x16_bf16 v[56:71], v[40:43], v[48:51], v[56:71]
    v_mfma_f32_32x32x16_bf16 v[72:87], v[40:43], v[52:55], v[72:87]
    v_mfma_f32_32x32x16_bf16 v[88:103], v[44:47], v[48:51], v[88:103]
    v_mfma_f32_32x32x16_bf16 v[104:119], v[44:47], v[52:55], v[104:119]
    s_add_u32 m0, s22, 114688
    s_nop 0
    buffer_load_dwordx4 v4, s[8:11], s16 offen lds
    buffer_load_dwordx4 v4, s[8:11], s16 offen offset:1024 lds
    s_add_u32 m0, s23, 139264
    s_add_u32 s16, s16, 16384
    buffer_load_dwordx4 v5, s[12:15], s17 offen lds
    s_add_u32 s17, s17, 65536
    s_add_u32 s39, s39, 1
    s_cmp_eq_u32 s39, 32
    s_cselect_b32 s12, s32, s12
    s_cselect_b32 s13, s33, s13
    s_cselect_b32 s14, s34, s14
    s_cselect_b32 s17, 0, s17
    ds_read_b64_tr_b16 v[40:41], v12 offset:10240
    ds_read_b64_tr_b16 v[42:43], v12 offset:10752
    ds_read_b64_tr_b16 v[44:45], v13 offset:10240
    ds_read_b64_tr_b16 v[46:47], v13 offset:10752
    ds_read_b128 v[48:51], v7 offset:16384
    ds_read_b128 v[52:55], v7 offset:18432
    s_waitcnt lgkmcnt(6)
    v_mfma_f32_32x32x16_bf16 v[56:71], v[24:27], v[32:35], v[56:71]
    v_mfma_f32_32x32x16_bf16 v[72:87], v[24:27], v[36:39], v[72:87]
    v_mfma_f32_32x32x16_bf16 v[88:103], v[28:31], v[32:35], v[88:103]
    v_mfma_f32_32x32x16_bf16 v[104:119], v[28:31], v[36:39], v[104:119]
    s_waitcnt lgkmcnt(0)
    v_mfma_f32_32x32x16_bf16 v[56:71], v[40:43], v[48:51], v[56:71]
    v_mfma_f32_32x32x16_bf16 v[72:87], v[40:43], v[52:55], v[72:87]
    v_mfma_f32_32x32x16_bf16 v[88:103], v[44:47], v[48:51], v[88:103]
    v_mfma_f32_32x32x16_bf16 v[104:119], v[44:47], v[52:55], v[104:119]
    s_waitcnt vmcnt(6)
    s_barrier
    ds_read_b64_tr_b16 v[24:25], v14 offset:0
    ds_read_b64_tr_b16 v[26:27], v14 offset:512
    ds_read_b64_tr_b16 v[28:29], v15 offset:0
    ds_read_b64_tr_b16 v[30:31], v15 offset:512
    ds_read_b128 v[32:35], v8 offset:0
    ds_read_b128 v[36:39], v8 offset:2048
    ds_read_b64_tr_b16 v[40:41], v14 offset:2048
    ds_read_b64_tr_b16 v[42:43], v14 offset:2560
    ds_read_b64_tr_b16 v[44:45], v15 offset:2048
    ds_read_b64_tr_b16 v[46:47], v15 offset:2560
    ds_read_b128 v[48:51], v9 offset:0
    ds_read_b128 v[52:55], v9 offset:2048
    s_waitcnt lgkmcnt(6)
    v_mfma_f32_32x32x16_bf16 v[56:71], v[24:27], v[32:35], v[56:71]
    v_mfma_f32_32x32x16_bf16 v[72:87], v[24:27], v[36:39], v[72:87]
    v_mfma_f32_32x32x16_bf16 v[88:103], v[28:31], v[32:35], v[88:103]
    v_mfma_f32_32x32x16_bf16 v[104:119], v[28:31], v[36:39], v[104:119]
    ds_read_b64_tr_b16 v[24:25], v14 offset:8192
    ds_read_b64_tr_b16 v[26:27], v14 offset:8704
    ds_read_b64_tr_b16 v[28:29], v15 offset:8192
    ds_read_b64_tr_b16 v[30:31], v15 offset:8704
    ds_read_b128 v[32:35], v8 offset:16384
    ds_read_b128 v[36:39], v8 offset:18432
    s_waitcnt lgkmcnt(6)
    v_mfma_f32_32x32x16_bf16 v[56:71], v[40:43], v[48:51], v[56:71]
    v_mfma_f32_32x32x16_bf16 v[72:87], v[40:43], v[52:55], v[72:87]
    v_mfma_f32_32x32x16_bf16 v[88:103], v[44:47], v[48:51], v[88:103]
    v_mfma_f32_32x32x16_bf16 v[104:119], v[44:47], v[52:55], v[104:119]
    ds_read_b64_tr_b16 v[40:41], v14 offset:10240
    ds_read_b64_tr_b16 v[42:43], v14 offset:10752
    ds_read_b64_tr_b16 v[44:45], v15 offset:10240
    ds_read_b64_tr_b16 v[46:47], v15 offset:10752
    ds_read_b128 v[48:51], v9 offset:16384
    ds_read_b128 v[52:55], v9 offset:18432
    s_waitcnt lgkmcnt(6)
    v_mfma_f32_32x32x16_bf16 v[56:71], v[24:27], v[32:35], v[56:71]
    v_mfma_f32_32x32x16_bf16 v[72:87], v[24:27], v[36:39], v[72:87]
    v_mfma_f32_32x32x16_bf16 v[88:103], v[28:31], v[32:35], v[88:103]
    v_mfma_f32_32x32x16_bf16 v[104:119], v[28:31], v[36:39], v[104:119]
    s_waitcnt lgkmcnt(0)
    v_mfma_f32_32x32x16_bf16 v[56:71], v[40:43], v[48:51], v[56:71]
    v_mfma_f32_32x32x16_bf16 v[72:87], v[40:43], v[52:55], v[72:87]
    v_mfma_f32_32x32x16_bf16 v[88:103], v[44:47], v[48:51], v[88:103]
    v_mfma_f32_32x32x16_bf16 v[104:119], v[44:47], v[52:55], v[104:119]
    s_waitcnt vmcnt(0)
    s_barrier
    ds_read_b64_tr_b16 v[24:25], v16 offset:0
    ds_read_b64_tr_b16 v[26:27], v16 offset:512
    ds_read_b64_tr_b16 v[28:29], v17 offset:0
    ds_read_b64_tr_b16 v[30:31], v17 offset:512
    ds_read_b128 v[32:35], v10 offset:0
    ds_read_b128 v[36:39], v10 offset:2048
    ds_read_b64_tr_b16 v[40:41], v16 offset:2048
    ds_read_b64_tr_b16 v[42:43], v16 offset:2560
    ds_read_b64_tr_b16 v[44:45], v17 offset:2048
    ds_read_b64_tr_b16 v[46:47], v17 offset:2560
    ds_read_b128 v[48:51], v11 offset:0
    ds_read_b128 v[52:55], v11 offset:2048
    s_waitcnt lgkmcnt(6)
    v_mfma_f32_32x32x16_bf16 v[56:71], v[24:27], v[32:35], v[56:71]
    v_mfma_f32_32x32x16_bf16 v[72:87], v[24:27], v[36:39], v[72:87]
    v_mfma_f32_32x32x16_bf16 v[88:103], v[28:31], v[32:35], v[88:103]
    v_mfma_f32_32x32x16_bf16 v[104:119], v[28:31], v[36:39], v[104:119]
    ds_read_b64_tr_b16 v[24:25], v16 offset:8192
    ds_read_b64_tr_b16 v[26:27], v16 offset:8704
    ds_read_b64_tr_b16 v[28:29], v17 offset:8192
    ds_read_b64_tr_b16 v[30:31], v17 offset:8704
    ds_read_b128 v[32:35], v10 offset:16384
    ds_read_b128 v[36:39], v10 offset:18432
    s_waitcnt lgkmcnt(6)
    v_mfma_f32_32x32x16_bf16 v[56:71], v[40:43], v[48:51], v[56:71]
    v_mfma_f32_32x32x16_bf16 v[72:87], v[40:43], v[52:55], v[72:87]
    v_mfma_f32_32x32x16_bf16 v[88:103], v[44:47], v[48:51], v[88:103]
    v_mfma_f32_32x32x16_bf16 v[104:119], v[44:47], v[52:55], v[104:119]
    ds_read_b64_tr_b16 v[40:41], v16 offset:10240
    ds_read_b64_tr_b16 v[42:43], v16 offset:10752
    ds_read_b64_tr_b16 v[44:45], v17 offset:10240
    ds_read_b64_tr_b16 v[46:47], v17 offset:10752
    ds_read_b128 v[48:51], v11 offset:16384
    ds_read_b128 v[52:55], v11 offset:18432
    s_waitcnt lgkmcnt(6)
    v_mfma_f32_32x32x16_bf16 v[56:71], v[24:27], v[32:35], v[56:71]
    v_mfma_f32_32x32x16_bf16 v[72:87], v[24:27], v[36:39], v[72:87]
    v_mfma_f32_32x32x16_bf16 v[88:103], v[28:31], v[32:35], v[88:103]
    v_mfma_f32_32x32x16_bf16 v[104:119], v[28:31], v[36:39], v[104:119]
    s_waitcnt lgkmcnt(0)
    v_mfma_f32_32x32x16_bf16 v[56:71], v[40:43], v[48:51], v[56:71]
    v_mfma_f32_32x32x16_bf16 v[72:87], v[40:43], v[52:55], v[72:87]
    v_mfma_f32_32x32x16_bf16 v[88:103], v[44:47], v[48:51], v[88:103]
    v_mfma_f32_32x32x16_bf16 v[104:119], v[44:47], v[52:55], v[104:119]
    s_nop 15
    s_nop 7
    s_add_u32 s8, s26, 67108864
    s_addc_u32 s9, s27, 0
    s_mov_b32 s10, 33554432
    s_lshl_b32 s35, s38, 6
    s_lshl_b32 s36, s30, 3
    s_add_u32 s35, s35, s36
    s_add_u32 s35, s35, s31
    s_lshl_b32 s35, s35, 3
    s_add_u32 s35, s35, s20
    s_lshl_b32 s35, s35, 14
    v_lshlrev_b32 v18, 4, v2
    buffer_store_dwordx4 v[56:59], v18, s[8:11], s35 offen offset:0
    buffer_store_dwordx4 v[60:63], v18, s[8:11], s35 offen offset:1024
    buffer_store_dwordx4 v[64:67], v18, s[8:11], s35 offen offset:2048
    buffer_store_dwordx4 v[68:71], v18, s[8:11], s35 offen offset:3072
    v_add_u32 v19, 4096, v18
    buffer_store_dwordx4 v[72:75], v19, s[8:11], s35 offen offset:0
    buffer_store_dwordx4 v[76:79], v19, s[8:11], s35 offen offset:1024
    buffer_store_dwordx4 v[80:83], v19, s[8:11], s35 offen offset:2048
    buffer_store_dwordx4 v[84:87], v19, s[8:11], s35 offen offset:3072
    v_add_u32 v20, 8192, v18
    buffer_store_dwordx4 v[88:91], v20, s[8:11], s35 offen offset:0
    buffer_store_dwordx4 v[92:95], v20, s[8:11], s35 offen offset:1024
    buffer_store_dwordx4 v[96:99], v20, s[8:11], s35 offen offset:2048
    buffer_store_dwordx4 v[100:103], v20, s[8:11], s35 offen offset:3072
    v_add_u32 v21, 12288, v18
    buffer_store_dwordx4 v[104:107], v21, s[8:11], s35 offen offset:0
    buffer_store_dwordx4 v[108:111], v21, s[8:11], s35 offen offset:1024
    buffer_store_dwordx4 v[112:115], v21, s[8:11], s35 offen offset:2048
    buffer_store_dwordx4 v[116:119], v21, s[8:11], s35 offen offset:3072
L_g2_done:
    s_endpgm
.globl comb_kernel
.p2align 8
.type comb_kernel,@function
comb_kernel:
    s_cmp_ge_u32 s2, 512
    s_cbranch_scc1 L_comb_done
    s_load_dwordx2 s[4:5], s[0:1], 0
    s_load_dwordx2 s[6:7], s[0:1], 56
    s_load_dwordx2 s[26:27], s[0:1], 72
    v_lshrrev_b32 v1, 6, v0
    v_and_b32 v2, 63, v0
    s_nop 0
    v_readfirstlane_b32 s20, v1
    s_lshl_b32 s3, s2, 2
    s_add_u32 s3, s3, s20
    s_lshl_b32 s3, s3, 12
    v_lshlrev_b32 v3, 4, v2
    s_waitcnt lgkmcnt(0)
    s_mov_b32 s8, s4
    s_mov_b32 s9, s5
    s_mov_b32 s10, 4194304
    s_mov_b32 s11, 0x00020000
    s_mov_b32 s12, s6
    s_mov_b32 s13, s7
    s_mov_b32 s14, 4194304
    s_mov_b32 s15, 0x00020000
    s_add_u32 s16, s26, 67108864
    s_addc_u32 s17, s27, 0
    s_mov_b32 s18, 33554432
    s_mov_b32 s19, 0x00020000
    s_add_u32 s21, s3, 0
    buffer_load_dwordx4 v[16:19], v3, s[16:19], s21 offen offset:0
    buffer_load_dwordx4 v[20:23], v3, s[16:19], s21 offen offset:1024
    buffer_load_dwordx4 v[24:27], v3, s[16:19], s21 offen offset:2048
    buffer_load_dwordx4 v[28:31], v3, s[16:19], s21 offen offset:3072
    s_add_u32 s21, s3, 8388608
    buffer_load_dwordx4 v[32:35], v3, s[16:19], s21 offen offset:0
    buffer_load_dwordx4 v[36:39], v3, s[16:19], s21 offen offset:1024
    buffer_load_dwordx4 v[40:43], v3, s[16:19], s21 offen offset:2048
    buffer_load_dwordx4 v[44:47], v3, s[16:19], s21 offen offset:3072
    s_add_u32 s21, s3, 16777216
    buffer_load_dwordx4 v[48:51], v3, s[16:19], s21 offen offset:0
    buffer_load_dwordx4 v[52:55], v3, s[16:19], s21 offen offset:1024
    buffer_load_dwordx4 v[56:59], v3, s[16:19], s21 offen offset:2048
    buffer_load_dwordx4 v[60:63], v3, s[16:19], s21 offen offset:3072
    s_add_u32 s21, s3, 25165824
    buffer_load_dwordx4 v[64:67], v3, s[16:19], s21 offen offset:0
    buffer_load_dwordx4 v[68:71], v3, s[16:19], s21 offen offset:1024
    buffer_load_dwordx4 v[72:75], v3, s[16:19], s21 offen offset:2048
    buffer_load_dwordx4 v[76:79], v3, s[16:19], s21 offen offset:3072
    s_lshr_b32 s22, s2, 6
    s_bfe_u32 s23, s2, 0x30003
    s_bfe_u32 s24, s2, 0x20001
    s_and_b32 s25, s2, 1
    s_lshr_b32 s28, s20, 1
    s_and_b32 s29, s20, 1
    s_lshl_b32 s30, s22, 8
    s_lshl_b32 s31, s24, 6
    s_add_u32 s30, s30, s31
    s_lshl_b32 s31, s29, 5
    s_add_u32 s30, s30, s31
    s_lshl_b32 s31, s23, 7
    s_lshl_b32 s32, s25, 6
    s_add_u32 s31, s31, s32
    s_lshl_b32 s32, s28, 5
    s_add_u32 s31, s31, s32
    v_and_b32 v4, 31, v2
    v_lshrrev_b32 v5, 5, v2
    v_add_u32 v4, s30, v4
    v_lshlrev_b32 v4, 11, v4
    v_lshl_add_u32 v5, v5, 2, s31
    v_lshl_add_u32 v4, v5, 1, v4
    buffer_load_dwordx2 v[8:9], v4, s[8:11], 0 offen offset:0
    buffer_load_dwordx2 v[10:11], v4, s[8:11], 0 offen offset:16
    buffer_load_dwordx2 v[12:13], v4, s[8:11], 0 offen offset:32
    buffer_load_dwordx2 v[14:15], v4, s[8:11], 0 offen offset:48
    s_waitcnt vmcnt(0)
    v_add_f32 v16, v16, v32
    v_add_f32 v48, v48, v64
    v_add_f32 v17, v17, v33
    v_add_f32 v49, v49, v65
    v_add_f32 v18, v18, v34
    v_add_f32 v50, v50, v66
    v_add_f32 v19, v19, v35
    v_add_f32 v51, v51, v67
    v_add_f32 v20, v20, v36
    v_add_f32 v52, v52, v68
    v_add_f32 v21, v21, v37
    v_add_f32 v53, v53, v69
    v_add_f32 v22, v22, v38
    v_add_f32 v54, v54, v70
    v_add_f32 v23, v23, v39
    v_add_f32 v55, v55, v71
    v_add_f32 v24, v24, v40
    v_add_f32 v56, v56, v72
    v_add_f32 v25, v25, v41
    v_add_f32 v57, v57, v73
    v_add_f32 v26, v26, v42
    v_add_f32 v58, v58, v74
    v_add_f32 v27, v27, v43
    v_add_f32 v59, v59, v75
    v_add_f32 v28, v28, v44
    v_add_f32 v60, v60, v76
    v_add_f32 v29, v29, v45
    v_add_f32 v61, v61, v77
    v_add_f32 v30, v30, v46
    v_add_f32 v62, v62, v78
    v_add_f32 v31, v31, v47
    v_add_f32 v63, v63, v79
    v_add_f32 v16, v16, v48
    v_add_f32 v17, v17, v49
    v_add_f32 v18, v18, v50
    v_add_f32 v19, v19, v51
    v_add_f32 v20, v20, v52
    v_add_f32 v21, v21, v53
    v_add_f32 v22, v22, v54
    v_add_f32 v23, v23, v55
    v_add_f32 v24, v24, v56
    v_add_f32 v25, v25, v57
    v_add_f32 v26, v26, v58
    v_add_f32 v27, v27, v59
    v_add_f32 v28, v28, v60
    v_add_f32 v29, v29, v61
    v_add_f32 v30, v30, v62
    v_add_f32 v31, v31, v63
    v_lshlrev_b32 v32, 16, v8
    v_and_b32 v33, 0xffff0000, v8
    v_lshlrev_b32 v34, 16, v9
    v_and_b32 v35, 0xffff0000, v9
    v_lshlrev_b32 v36, 16, v10
    v_and_b32 v37, 0xffff0000, v10
    v_lshlrev_b32 v38, 16, v11
    v_and_b32 v39, 0xffff0000, v11
    v_lshlrev_b32 v40, 16, v12
    v_and_b32 v41, 0xffff0000, v12
    v_lshlrev_b32 v42, 16, v13
    v_and_b32 v43, 0xffff0000, v13
    v_lshlrev_b32 v44, 16, v14
    v_and_b32 v45, 0xffff0000, v14
    v_lshlrev_b32 v46, 16, v15
    v_and_b32 v47, 0xffff0000, v15
    v_add_f32 v16, v16, v32
    v_add_f32 v17, v17, v33
    v_add_f32 v18, v18, v34
    v_add_f32 v19, v19, v35
    v_add_f32 v20, v20, v36
    v_add_f32 v21, v21, v37
    v_add_f32 v22, v22, v38
    v_add_f32 v23, v23, v39
    v_add_f32 v24, v24, v40
    v_add_f32 v25, v25, v41
    v_add_f32 v26, v26, v42
    v_add_f32 v27, v27, v43
    v_add_f32 v28, v28, v44
    v_add_f32 v29, v29, v45
    v_add_f32 v30, v30, v46
    v_add_f32 v31, v31, v47
    v_cvt_pk_bf16_f32 v8, v16, v17
    v_cvt_pk_bf16_f32 v9, v18, v19
    buffer_store_dwordx2 v[8:9], v4, s[12:15], 0 offen offset:0
    v_cvt_pk_bf16_f32 v10, v20, v21
    v_cvt_pk_bf16_f32 v11, v22, v23
    buffer_store_dwordx2 v[10:11], v4, s[12:15], 0 offen offset:16
    v_cvt_pk_bf16_f32 v12, v24, v25
    v_cvt_pk_bf16_f32 v13, v26, v27
    buffer_store_dwordx2 v[12:13], v4, s[12:15], 0 offen offset:32
    v_cvt_pk_bf16_f32 v14, v28, v29
    v_cvt_pk_bf16_f32 v15, v30, v31
    buffer_store_dwordx2 v[14:15], v4, s[12:15], 0 offen offset:48
L_comb_done:
    s_endpgm
.section .rodata,"a"
.p2align 6
.amdhsa_kernel ln_kernel
  .amdhsa_next_free_vgpr 48
  .amdhsa_next_free_sgpr 102
  .amdhsa_accum_offset 48
  .amdhsa_group_segment_fixed_size 0
  .amdhsa_kernarg_size 80
  .amdhsa_user_sgpr_count 2
  .amdhsa_user_sgpr_kernarg_segment_ptr 1
  .amdhsa_system_sgpr_workgroup_id_x 1
.end_amdhsa_kernel
.p2align 6
.amdhsa_kernel gemm1_kernel
  .amdhsa_next_free_vgpr 252
  .amdhsa_next_free_sgpr 102
  .amdhsa_accum_offset 252
  .amdhsa_group_segment_fixed_size 0
  .amdhsa_kernarg_size 80
  .amdhsa_user_sgpr_count 2
  .amdhsa_user_sgpr_kernarg_segment_ptr 1
  .amdhsa_system_sgpr_workgroup_id_x 1
.end_amdhsa_kernel
.p2align 6
.amdhsa_kernel attn_kernel
  .amdhsa_next_free_vgpr 256
  .amdhsa_next_free_sgpr 102
  .amdhsa_accum_offset 256
  .amdhsa_group_segment_fixed_size 0
  .amdhsa_kernarg_size 80
  .amdhsa_user_sgpr_count 2
  .amdhsa_user_sgpr_kernarg_segment_ptr 1
  .amdhsa_system_sgpr_workgroup_id_x 1
.end_amdhsa_kernel
.p2align 6
.amdhsa_kernel gemm2_kernel
  .amdhsa_next_free_vgpr 120
  .amdhsa_next_free_sgpr 102
  .amdhsa_accum_offset 120
  .amdhsa_group_segment_fixed_size 0
  .amdhsa_kernarg_size 80
  .amdhsa_user_sgpr_count 2
  .amdhsa_user_sgpr_kernarg_segment_ptr 1
  .amdhsa_system_sgpr_workgroup_id_x 1
.end_amdhsa_kernel
.p2align 6
.amdhsa_kernel comb_kernel
  .amdhsa_next_free_vgpr 80
  .amdhsa_next_free_sgpr 102
  .amdhsa_accum_offset 80
  .amdhsa_group_segment_fixed_size 0
  .amdhsa_kernarg_size 80
  .amdhsa_user_sgpr_count 2
  .amdhsa_user_sgpr_kernarg_segment_ptr 1
  .amdhsa_system_sgpr_workgroup_id_x 1
.end_amdhsa_kernel
```
